```python
import torch

def _softmax(x, axis=-1):
    return torch.softmax(x, dim=axis)
def _gelu(x):
    return torch.nn.functional.gelu(x, approximate="tanh")
def _silu(x):
    return torch.nn.functional.silu(x)
def _sigmoid(x):
    return torch.sigmoid(x)
def _layernorm(x, axis=-1, eps=1e-5):
    m = x.mean(dim=axis, keepdim=True)
    v = x.var(dim=axis, keepdim=True, unbiased=False)
    return (x - m) / torch.sqrt(v + eps)
def _scatter_add(tgt, idx, src, axis=0):
    return tgt.clone().index_add_(axis, idx, src)
def _segment_sum(src, seg, n):
    out = torch.zeros((n,) + src.shape[1:], dtype=src.dtype)
    return out.index_add_(0, seg, src)
def _pad(x, pw):
    flat = tuple(v for pair in reversed(pw) for v in pair)
    return torch.nn.functional.pad(x, flat)

kernel_name = 'parallel_sum__softmax_full_mha__moe_arch_mod__prompt'

def setup_inputs():

    _w = (lambda a: (lambda t: t.to(torch.bfloat16) if t.is_floating_point() else t)(torch.as_tensor(a)))
    def _A_setup():
        B, S, D = 1, 2048, 640
        return {
            "x": _w((lambda *s: torch.randn(*s, dtype=torch.bfloat16) * 0.05)(B, S, D)),
            "wqkv": _w((lambda *s: torch.randn(*s, dtype=torch.bfloat16) * 0.1)(D, 3 * D)),
            "wo": _w((lambda *s: torch.randn(*s, dtype=torch.bfloat16) * 0.05)(D, D)),
        }
    _A_in = _A_setup()

    def _B_setup():
        B, S, D, F, C = 1, 2048, 640, 1536, 2
        return {
            "x": _w((lambda *s: torch.randn(*s, dtype=torch.bfloat16) * 0.05)(B, S, D)),
            "w_r": _w((lambda *s: torch.randn(*s, dtype=torch.bfloat16) * 3.2)(D)),
            "w_gate": _w((lambda *s: torch.randn(*s, dtype=torch.bfloat16) * 0.1)(D, F)),
            "w_up": _w((lambda *s: torch.randn(*s, dtype=torch.bfloat16) * 0.1)(D, F)),
            "w_down": _w((lambda *s: torch.randn(*s, dtype=torch.bfloat16) * 0.1)(F, D)),
        }
    _B_in = _B_setup()

    return {
        "A_x": _A_in["x"],
        "A_wqkv": _A_in["wqkv"],
        "A_wo": _A_in["wo"],
        "B_x": _B_in["x"],
        "B_w_r": _B_in["w_r"],
        "B_w_gate": _B_in["w_gate"],
        "B_w_up": _B_in["w_up"],
        "B_w_down": _B_in["w_down"],
    }

def reference(A_x, A_wqkv, A_wo, B_x, B_w_r, B_w_gate, B_w_up, B_w_down):
    def _A_ref(x, wqkv, wo):
        B, S, D = x.shape
        H = 32; Dh = D // H
        qkv = (lambda x, *d: x.permute(*d))((x @ wqkv).reshape(B, S, 3, H, Dh), 2, 0, 3, 1, 4)
        q, k, v = qkv[0], qkv[1], qkv[2]
        scale = Dh ** -0.5
        scores = torch.einsum("bhqd,bhkd->bhqk", q, k) * scale
        p = _softmax(scores, axis=-1)
        o = torch.einsum("bhqk,bhkd->bhqd", p, v)
        return (lambda x, *d: x.permute(*d))(o, 0, 2, 1, 3).reshape(B, S, D) @ wo

    def _B_ref(x, w_r, w_gate, w_up, w_down):
        B, S, D = x.shape
        C = 2
        r = x @ w_r
        idx = torch.argsort(-r, axis=-1)[:, :C]
        idx_e = (lambda x, n, axis: torch.repeat_interleave(x, n, dim=axis))(idx.reshape(B, C, 1), D, axis=2)
        x_sel = (lambda x, i, axis: torch.take_along_dim(x, i, dim=axis))(x, idx_e, axis=1)
        g = _silu(x_sel @ w_gate)
        u = x_sel @ w_up
        y = (g * u) @ w_down
        r_sel = _sigmoid((lambda x, i, axis: torch.take_along_dim(x, i, dim=axis))(r, idx, axis=1))
        y = y * r_sel.reshape(B, C, 1)
        b_off = (torch.arange(B) * S).reshape(B, 1)
        flat_idx = (idx + b_off).reshape(B * C)
        zero = (x * 0.0).reshape(B * S, D)
        upd = _scatter_add(zero, flat_idx, y.reshape(B * C, D), axis=0)
        return x + upd.reshape(B, S, D)

    x = A_x
    xn = _layernorm(x, axis=-1)
    return x + _A_ref(xn, A_wqkv, A_wo) + _B_ref(xn, B_w_r, B_w_gate, B_w_up, B_w_down)
```

```asm
; @launch grid=(256,1,1) block=(512,1,1) lds=163840
.amdgcn_target "amdgcn-amd-amdhsa--gfx950"
.text
.globl parallel_sum__softmax_full_mha__moe_arch_mod__prompt_kernel
.p2align 8
.type parallel_sum__softmax_full_mha__moe_arch_mod__prompt_kernel,@function
parallel_sum__softmax_full_mha__moe_arch_mod__prompt_kernel:
    s_cmp_ge_u32 s2, 256
    s_cbranch_scc1 P_END
    s_load_dwordx16 s[64:79], s[0:1], 0
    s_load_dwordx4 s[80:83], s[0:1], 64
    s_load_dwordx2 s[84:85], s[0:1], 80
    v_lshrrev_b32 v1, 6, v0
    v_and_b32 v0, 63, v0
    v_readfirstlane_b32 s3, v1
    v_lshlrev_b32 v1, 4, v0
KSTART:
    s_cmp_lg_u32 s3, 0
    s_cbranch_scc1 CPF1
    s_getpc_b64 s[14:15]
CPC1:
    s_sub_u32 s14, s14, CPC1-KSTART
    s_subb_u32 s15, s15, 0
    s_lshr_b32 s16, s2, 3
    s_mul_i32 s16, s16, 1152
    v_lshlrev_b32 v2, 7, v0
    v_add_u32 v2, s16, v2
    v_min_u32 v2, K_END-KSTART-4, v2
    s_mov_b64 exec, 0x1ff
    global_load_dword v243, v2, s[14:15]
    s_mov_b64 exec, -1
CPF1:
    s_lshr_b32 s15, s2, 3
    s_bfe_u32 s17, s2, 0x10002
    s_and_b32 s16, s15, 3
    s_lshr_b32 s18, s15, 2
    s_lshl_b32 s19, s17, 3
    s_add_u32 s21, s18, s19
    s_lshl_b32 s17, s17, 1
    s_and_b32 s19, s15, 1
    s_add_u32 s17, s17, s19
    s_cmp_ge_u32 s15, 28
    s_cselect_b32 s16, s17, s16
    s_cselect_b32 s21, 7, s21
    s_cmp_ge_u32 s15, 30
    s_cselect_b32 s21, 15, s21
    s_and_b32 s14, s2, 3
    s_lshl_b32 s14, s14, 2
    s_add_u32 s20, s14, s16
    s_cmp_eq_u32 s21, 15
    s_cbranch_scc1 P1_AUX
    s_cmp_lt_u32 s3, 4
    s_cbranch_scc1 P1_COMP
    s_sub_u32 s36, s3, 4
    v_lshrrev_b32 v10, 3, v0
    v_mul_u32_u24 v10, 1280, v10
    v_and_b32 v11, 7, v0
    v_lshrrev_b32 v12, 4, v0
    v_xor_b32 v13, v11, v12
    v_xor_b32 v14, 4, v13
    v_lshl_add_u32 v2, v13, 4, v10
    v_lshl_add_u32 v4, v14, 4, v10
    v_add_u32 v3, 9216, v2
    v_add_u32 v5, 27648, v4
    v_add_u32 v4, 18432, v4
    v_mul_u32_u24 v10, 3840, v12
    v_and_b32 v11, 15, v0
    v_lshlrev_b32 v12, 2, v12
    v_xor_b32 v11, v11, v12
    v_xor_b32 v12, 2, v11
    v_lshl_add_u32 v6, v11, 4, v10
    v_lshl_add_u32 v8, v12, 4, v10
    v_add_u32 v7, 14336, v6
    v_add_u32 v9, 43008, v8
    v_add_u32 v8, 28672, v8
    s_lshl_b32 s14, s20, 2
    s_add_u32 s14, s14, s36
    s_mul_i32 s37, s14, 40960
    s_mul_i32 s38, s36, 61440
    s_lshl_b32 s14, s21, 8
    s_add_u32 s38, s38, s14
    s_mul_i32 s14, s20, 3
    s_add_u32 s14, s14, s21
    s_mul_i32 s15, s14, 205
    s_lshr_b32 s15, s15, 11
    s_mul_i32 s15, s15, 10
    s_sub_u32 s39, s14, s15
    s_lshr_b32 s14, s2, 3
    s_and_b32 s15, s14, 3
    s_mul_i32 s15, s15, 5
    s_lshr_b32 s14, s14, 2
    s_mul_i32 s14, s14, 5
    s_add_u32 s14, s14, s15
    s_and_b32 s15, s2, 3
    s_mul_i32 s15, s15, 2
    s_add_u32 s14, s14, s15
    s_bfe_u32 s15, s2, 0x10002
    s_mul_i32 s15, s15, 1
    s_add_u32 s14, s14, s15
    s_mul_i32 s15, s14, 205
    s_lshr_b32 s15, s15, 11
    s_mul_i32 s15, s15, 10
    s_sub_u32 s39, s14, s15
    s_lshl_b32 s40, s36, 12
    s_mov_b32 s43, 0
    s_waitcnt lgkmcnt(0)
    s_mov_b32 s24, s64
    s_mov_b32 s25, s65
    s_mov_b32 s26, 2621440
    s_mov_b32 s27, 0x00020000
    s_mov_b32 s28, s66
    s_mov_b32 s29, s67
    s_mov_b32 s30, 2457600
    s_mov_b32 s31, 0x00020000
    s_cmp_eq_u32 s3, 4
    s_cselect_b32 s44, 9, -1
P1_LD:
    s_cmp_lt_u32 s43, 2
    s_cbranch_scc1 P1_LD2
    s_waitcnt vmcnt(8)
    s_barrier
P1_LD2:
    s_cmp_lg_u32 s43, s44
    s_cbranch_scc1 P1_LD6
    s_mov_b32 s60, s84
    s_mov_b32 s61, s85
    s_mov_b32 s62, 11829248
    s_mov_b32 s63, 0x00020000
    s_mov_b32 s32, s82
    s_mov_b32 s33, s83
    s_mov_b32 s34, 256
    s_mov_b32 s35, 0x00020000
    v_mov_b32 v10, 192
    s_and_b32 s14, s2, 7
    s_lshl_b32 s14, s14, 1
    s_bfe_u32 s15, s2, 0x10004
    s_add_u32 s14, s14, s15
    s_sub_u32 s14, s14, s20
    v_and_b32 v12, 1, v0
    v_mul_i32_i24 v12, s14, v12
    v_add_u32 v12, s20, v12
    v_lshlrev_b32 v12, 8, v12
    v_add_u32 v12, 10977280, v12
    buffer_load_dword v11, v10, s[32:35], 0 offen sc1
P1_LD6:
    s_lshl_b32 s41, s39, 7
    s_add_u32 s41, s41, s37
    s_mov_b32 m0, s40
    s_mul_i32 s42, s39, 245760
    buffer_load_dwordx4 v2, s[24:27], s41 offen offset:0 lds
    buffer_load_dwordx4 v3, s[24:27], s41 offen offset:1024 lds
    buffer_load_dwordx4 v4, s[24:27], s41 offen offset:2048 lds
    buffer_load_dwordx4 v5, s[24:27], s41 offen offset:3072 lds
    s_add_u32 s42, s42, s38
    s_add_u32 m0, s40, 16384
    s_add_u32 s39, s39, 1
    buffer_load_dwordx4 v6, s[28:31], s42 offen offset:0 lds
    buffer_load_dwordx4 v7, s[28:31], s42 offen offset:1024 lds
    buffer_load_dwordx4 v8, s[28:31], s42 offen offset:2048 lds
    buffer_load_dwordx4 v9, s[28:31], s42 offen offset:3072 lds
    s_cmp_eq_u32 s39, 10
    s_cselect_b32 s39, 0, s39
    s_add_u32 s40, s40, 32768
    s_and_b32 s40, s40, 0x1ffff
    s_add_u32 s43, s43, 1
    s_cmp_lt_u32 s43, 10
    s_cbranch_scc1 P1_LD
    s_mov_b32 s60, s84
    s_mov_b32 s61, s85
    s_mov_b32 s62, 11829248
    s_mov_b32 s63, 0x00020000
    s_mov_b32 s32, s82
    s_mov_b32 s33, s83
    s_mov_b32 s34, 256
    s_mov_b32 s35, 0x00020000
    v_mov_b32 v10, 192
    s_and_b32 s14, s2, 7
    s_lshl_b32 s14, s14, 1
    s_bfe_u32 s15, s2, 0x10004
    s_add_u32 s14, s14, s15
    s_sub_u32 s14, s14, s20
    v_and_b32 v12, 1, v0
    v_mul_i32_i24 v12, s14, v12
    v_add_u32 v12, s20, v12
    v_lshlrev_b32 v12, 8, v12
    v_add_u32 v12, 10977280, v12
    s_waitcnt vmcnt(8)
    s_barrier
    s_cmp_lg_u32 s3, 4
    s_cbranch_scc1 P1_LD5
    v_mov_b32 v13, 0
    v_cmp_eq_u32 vcc, 0, v11
    s_nop 0
    s_cbranch_vccnz P1_LD5
    buffer_load_dword v13, v12, s[60:63], 0 offen sc1
P1_LD5:
    s_waitcnt vmcnt(0)
    s_barrier
    s_cmp_lg_u32 s3, 4
    s_cbranch_scc1 P1_LD3
    v_cmp_eq_u32 vcc, 0, v13
    s_nop 0
    s_cbranch_vccz P1_LD4
    v_cmp_eq_u32 vcc, 0, v11
    s_nop 0
    s_cbranch_vccz P1_LD7
    s_mov_b32 s14, 0
POLL1:
    buffer_load_dword v11, v10, s[32:35], 0 offen sc1
    s_add_u32 s14, s14, 1
    s_cmp_gt_u32 s14, 200000
    s_cbranch_scc1 POLLX1
    s_waitcnt vmcnt(0)
    v_cmp_eq_u32 vcc, 0, v11
    s_nop 0
    s_mov_b64 exec, vcc
    s_cbranch_execnz POLL1
POLLX1:
    s_mov_b64 exec, -1
    s_waitcnt vmcnt(0)
P1_LD7:
    s_mov_b32 s14, 0
POLL2:
    buffer_load_dword v13, v12, s[60:63], 0 offen sc1
    s_add_u32 s14, s14, 1
    s_cmp_gt_u32 s14, 200000
    s_cbranch_scc1 POLLX2
    s_waitcnt vmcnt(0)
    v_cmp_eq_u32 vcc, 0, v13
    s_nop 0
    s_mov_b64 exec, vcc
    s_cbranch_execnz POLL2
POLLX2:
    s_mov_b64 exec, -1
    s_waitcnt vmcnt(0)
P1_LD4:
    s_lshl_b32 s14, s20, 10
    s_add_u32 s14, s14, 10485760
    s_cmp_lg_u32 s3, 4
    s_cbranch_scc1 P1_LD3
    buffer_load_dwordx4 v[240:243], v1, s[60:63], s14 offen sc1
P1_LD3:
    s_lshl_b32 s14, s21, 4
    s_add_u32 s14, s14, s20
    s_lshl_b32 s14, s14, 8
    s_add_u32 s57, s14, 10551296
    s_branch P2_PREP
P1_COMP:
    s_setprio 1
    s_waitcnt lgkmcnt(0)
    s_mov_b32 s60, s84
    s_mov_b32 s61, s85
    s_mov_b32 s62, 11829248
    s_mov_b32 s63, 0x00020000
    s_lshr_b32 s36, s3, 1
    s_and_b32 s37, s3, 1
    v_and_b32 v10, 15, v0
    v_lshrrev_b32 v11, 4, v0
    v_and_b32 v13, 8, v0
    v_add_u32 v12, v10, v13
    v_bfe_u32 v13, v0, 1, 2
    v_bfe_u32 v14, v0, 3, 1
    v_lshl_add_u32 v13, v14, 2, v13
    v_xor_b32 v13, v13, v11
    s_lshl_b32 s14, s36, 13
    v_lshl_add_u32 v14, v12, 7, s14
    v_lshl_add_u32 v17, v13, 4, v14
    v_xor_b32 v18, 64, v17
    v_bfe_u32 v13, v0, 2, 2
    v_lshl_add_u32 v14, v11, 3, v13
    v_lshlrev_b32 v14, 8, v14
    v_add_u32 v14, 16384, v14
    v_lshlrev_b32 v13, 2, v13
    v_and_b32 v15, 1, v11
    v_lshl_add_u32 v13, v15, 1, v13
    s_lshl_b32 s14, s37, 1
    s_add_u32 s14, s14, s36
    s_lshl_b32 s14, s14, 2
    v_xor_b32 v13, s14, v13
    v_mov_b32 v40, 0
    v_mov_b32 v41, 0
    v_pk_mov_b32 v[42:43], v[40:41], v[40:41]
    v_pk_mov_b32 v[44:45], v[40:41], v[40:41]
    v_pk_mov_b32 v[46:47], v[40:41], v[40:41]
    v_pk_mov_b32 v[48:49], v[40:41], v[40:41]
    v_pk_mov_b32 v[50:51], v[40:41], v[40:41]
    v_pk_mov_b32 v[52:53], v[40:41], v[40:41]
    v_pk_mov_b32 v[54:55], v[40:41], v[40:41]
    v_pk_mov_b32 v[56:57], v[40:41], v[40:41]
    v_pk_mov_b32 v[58:59], v[40:41], v[40:41]
    v_pk_mov_b32 v[60:61], v[40:41], v[40:41]
    v_pk_mov_b32 v[62:63], v[40:41], v[40:41]
    v_pk_mov_b32 v[64:65], v[40:41], v[40:41]
    v_pk_mov_b32 v[66:67], v[40:41], v[40:41]
    v_pk_mov_b32 v[68:69], v[40:41], v[40:41]
    v_pk_mov_b32 v[70:71], v[40:41], v[40:41]
    v_pk_mov_b32 v[72:73], v[40:41], v[40:41]
    v_pk_mov_b32 v[74:75], v[40:41], v[40:41]
    v_pk_mov_b32 v[76:77], v[40:41], v[40:41]
    v_pk_mov_b32 v[78:79], v[40:41], v[40:41]
    v_pk_mov_b32 v[80:81], v[40:41], v[40:41]
    v_pk_mov_b32 v[82:83], v[40:41], v[40:41]
    v_pk_mov_b32 v[84:85], v[40:41], v[40:41]
    v_pk_mov_b32 v[86:87], v[40:41], v[40:41]
    v_pk_mov_b32 v[88:89], v[40:41], v[40:41]
    v_pk_mov_b32 v[90:91], v[40:41], v[40:41]
    v_pk_mov_b32 v[92:93], v[40:41], v[40:41]
    v_pk_mov_b32 v[94:95], v[40:41], v[40:41]
    v_pk_mov_b32 v[96:97], v[40:41], v[40:41]
    v_pk_mov_b32 v[98:99], v[40:41], v[40:41]
    v_pk_mov_b32 v[100:101], v[40:41], v[40:41]
    v_pk_mov_b32 v[102:103], v[40:41], v[40:41]
    v_pk_mov_b32 v[28:29], v[40:41], v[40:41]
    v_pk_mov_b32 v[30:31], v[40:41], v[40:41]
    v_pk_mov_b32 v[32:33], v[40:41], v[40:41]
    v_pk_mov_b32 v[34:35], v[40:41], v[40:41]
    v_and_b32 v15, 3, v0
    v_cmp_eq_u32 vcc, 0, v15
    v_mov_b32 v16, 1065369472
    s_nop 0
    v_cndmask_b32 v36, 0, v16, vcc
    v_mov_b32 v37, v36
    v_mov_b32 v38, v36
    v_mov_b32 v39, v36
    s_lshl_b32 s14, s20, 2
    s_lshl_b32 s15, s36, 1
    s_add_u32 s44, s14, s15
    s_add_u32 s45, s44, 1
    s_cmp_ge_u32 s21, 10
    s_cbranch_scc1 P1_V
    v_and_b32 v15, 3, v0
    v_xor_b32 v13, v13, v15
    v_lshl_add_u32 v19, v13, 4, v14
    v_add_u32 v20, 8, v19
    v_xor_b32 v21, 64, v19
    v_xor_b32 v22, 64, v20
    s_mov_b32 s40, 1024
    s_mov_b32 s41, 65536
    s_mov_b32 s43, 2097152
    s_cmp_ge_u32 s21, 5
    s_cselect_b32 s40, 2304, s40
    s_cselect_b32 s41, 147456, s41
    s_cselect_b32 s42, 2621440, 0
    s_cselect_b32 s43, 7340032, s43
    s_cselect_b32 s14, 5, 0
    s_sub_u32 s14, s21, s14
    s_lshl_b32 s14, s14, 2
    s_lshl_b32 s15, s37, 1
    s_add_u32 s14, s14, s15
    s_add_u32 s14, s14, s36
    s_lshl_b32 s15, s14, 2
    v_add_u32 v13, s15, v11
    v_mul_u32_u24 v14, 205, v13
    v_lshrrev_b32 v14, 10, v14
    v_mul_u32_u24 v15, 5, v14
    v_sub_u32 v13, v13, v15
    v_cmp_lt_u32 vcc, 2, v13
    v_lshlrev_b32 v15, 1, v14
    v_subrev_u32 v16, 3, v13
    v_addc_co_u32 v15, s[16:17], 0, v15, vcc
    v_cndmask_b32 v16, v13, v16, vcc
    v_mul_u32_u24 v168, s41, v15
    v_lshl_add_u32 v168, v16, 9, v168
    v_add_u32 v168, s42, v168
    v_lshlrev_b32 v169, 15, v14
    v_add_u32 v169, s43, v169
    v_cmp_eq_u32 vcc, 2, v13
    v_mov_b32 v170, s40
    v_mov_b32 v171, 512
    v_cndmask_b32 v168, v168, v169, vcc
    v_cndmask_b32 v170, v170, v171, vcc
    v_lshl_add_u32 v168, v12, 4, v168
    v_mad_u32_u24 v23, v170, s44, v168
    v_mad_u32_u24 v25, v170, s45, v168
    s_xor_b32 s14, s14, 1
    s_lshl_b32 s15, s14, 2
    v_add_u32 v13, s15, v11
    v_mul_u32_u24 v14, 205, v13
    v_lshrrev_b32 v14, 10, v14
    v_mul_u32_u24 v15, 5, v14
    v_sub_u32 v13, v13, v15
    v_cmp_lt_u32 vcc, 2, v13
    v_lshlrev_b32 v15, 1, v14
    v_subrev_u32 v16, 3, v13
    v_addc_co_u32 v15, s[16:17], 0, v15, vcc
    v_cndmask_b32 v16, v13, v16, vcc
    v_mul_u32_u24 v168, s41, v15
    v_lshl_add_u32 v168, v16, 9, v168
    v_add_u32 v168, s42, v168
    v_lshlrev_b32 v169, 15, v14
    v_add_u32 v169, s43, v169
    v_cmp_eq_u32 vcc, 2, v13
    v_mov_b32 v170, s40
    v_mov_b32 v171, 512
    v_cndmask_b32 v168, v168, v169, vcc
    v_cndmask_b32 v170, v170, v171, vcc
    v_lshl_add_u32 v168, v12, 4, v168
    v_mad_u32_u24 v24, v170, s44, v168
    v_mad_u32_u24 v26, v170, s45, v168
    s_mov_b32 s38, 0
    s_barrier
    ds_read_b128 v[104:107], v17 offset:0
    ds_read_b64_tr_b16 v[136:137], v19 offset:0
    ds_read_b64_tr_b16 v[138:139], v19 offset:1024
    ds_read_b128 v[108:111], v17 offset:1024
    ds_read_b64_tr_b16 v[140:141], v20 offset:0
    ds_read_b64_tr_b16 v[142:143], v20 offset:1024
    ds_read_b128 v[112:115], v17 offset:4096
    ds_read_b64_tr_b16 v[144:145], v21 offset:0
    ds_read_b64_tr_b16 v[146:147], v21 offset:1024
    ds_read_b128 v[116:119], v17 offset:5120
    ds_read_b64_tr_b16 v[148:149], v22 offset:0
    ds_read_b64_tr_b16 v[150:151], v22 offset:1024
P1_LOOPQK:
    s_waitcnt lgkmcnt(0)
    v_mfma_f32_16x16x32_bf16 v[40:43], v[136:139], v[104:107], v[40:43]
    ds_read_b128 v[120:123], v18 offset:0
    v_mfma_f32_16x16x32_bf16 v[44:47], v[140:143], v[104:107], v[44:47]
    ds_read_b64_tr_b16 v[152:153], v19 offset:8192
    v_mfma_f32_16x16x32_bf16 v[56:59], v[136:139], v[108:111], v[56:59]
    ds_read_b64_tr_b16 v[154:155], v19 offset:9216
    v_mfma_f32_16x16x32_bf16 v[48:51], v[144:147], v[104:107], v[48:51]
    ds_read_b128 v[124:127], v18 offset:1024
    v_mfma_f32_16x16x32_bf16 v[60:63], v[140:143], v[108:111], v[60:63]
    ds_read_b64_tr_b16 v[156:157], v20 offset:8192
    v_mfma_f32_16x16x32_bf16 v[72:75], v[136:139], v[112:115], v[72:75]
    ds_read_b64_tr_b16 v[158:159], v20 offset:9216
    v_mfma_f32_16x16x32_bf16 v[52:55], v[148:151], v[104:107], v[52:55]
    ds_read_b128 v[128:131], v18 offset:4096
    v_mfma_f32_16x16x32_bf16 v[64:67], v[144:147], v[108:111], v[64:67]
    ds_read_b64_tr_b16 v[160:161], v21 offset:8192
    v_mfma_f32_16x16x32_bf16 v[76:79], v[140:143], v[112:115], v[76:79]
    ds_read_b64_tr_b16 v[162:163], v21 offset:9216
    v_mfma_f32_16x16x32_bf16 v[88:91], v[136:139], v[116:119], v[88:91]
    ds_read_b128 v[132:135], v18 offset:5120
    v_mfma_f32_16x16x32_bf16 v[68:71], v[148:151], v[108:111], v[68:71]
    ds_read_b64_tr_b16 v[164:165], v22 offset:8192
    v_mfma_f32_16x16x32_bf16 v[80:83], v[144:147], v[112:115], v[80:83]
    ds_read_b64_tr_b16 v[166:167], v22 offset:9216
    v_mfma_f32_16x16x32_bf16 v[92:95], v[140:143], v[116:119], v[92:95]
    v_mfma_f32_16x16x32_bf16 v[28:31], v[36:39], v[136:139], v[28:31]
    v_mfma_f32_16x16x32_bf16 v[84:87], v[148:151], v[112:115], v[84:87]
    v_mfma_f32_16x16x32_bf16 v[96:99], v[144:147], v[116:119], v[96:99]
    v_mfma_f32_16x16x32_bf16 v[32:35], v[36:39], v[140:143], v[32:35]
    v_mfma_f32_16x16x32_bf16 v[100:103], v[148:151], v[116:119], v[100:103]
    s_waitcnt lgkmcnt(0)
    s_barrier
    v_mfma_f32_16x16x32_bf16 v[40:43], v[152:155], v[120:123], v[40:43]
    ds_read_b128 v[104:107], v17 offset:32768
    v_mfma_f32_16x16x32_bf16 v[44:47], v[156:159], v[120:123], v[44:47]
    ds_read_b64_tr_b16 v[136:137], v19 offset:32768
    v_mfma_f32_16x16x32_bf16 v[56:59], v[152:155], v[124:127], v[56:59]
    ds_read_b64_tr_b16 v[138:139], v19 offset:33792
    v_mfma_f32_16x16x32_bf16 v[48:51], v[160:163], v[120:123], v[48:51]
    ds_read_b128 v[108:111], v17 offset:33792
    v_mfma_f32_16x16x32_bf16 v[60:63], v[156:159], v[124:127], v[60:63]
    ds_read_b64_tr_b16 v[140:141], v20 offset:32768
    v_mfma_f32_16x16x32_bf16 v[72:75], v[152:155], v[128:131], v[72:75]
    ds_read_b64_tr_b16 v[142:143], v20 offset:33792
    v_mfma_f32_16x16x32_bf16 v[52:55], v[164:167], v[120:123], v[52:55]
    ds_read_b128 v[112:115], v17 offset:36864
    v_mfma_f32_16x16x32_bf16 v[64:67], v[160:163], v[124:127], v[64:67]
    ds_read_b64_tr_b16 v[144:145], v21 offset:32768
    v_mfma_f32_16x16x32_bf16 v[76:79], v[156:159], v[128:131], v[76:79]
    ds_read_b64_tr_b16 v[146:147], v21 offset:33792
    v_mfma_f32_16x16x32_bf16 v[88:91], v[152:155], v[132:135], v[88:91]
    ds_read_b128 v[116:119], v17 offset:37888
    v_mfma_f32_16x16x32_bf16 v[68:71], v[164:167], v[124:127], v[68:71]
    ds_read_b64_tr_b16 v[148:149], v22 offset:32768
    v_mfma_f32_16x16x32_bf16 v[80:83], v[160:163], v[128:131], v[80:83]
    ds_read_b64_tr_b16 v[150:151], v22 offset:33792
    v_mfma_f32_16x16x32_bf16 v[92:95], v[156:159], v[132:135], v[92:95]
    v_mfma_f32_16x16x32_bf16 v[28:31], v[36:39], v[152:155], v[28:31]
    v_mfma_f32_16x16x32_bf16 v[84:87], v[164:167], v[128:131], v[84:87]
    v_mfma_f32_16x16x32_bf16 v[96:99], v[160:163], v[132:135], v[96:99]
    v_mfma_f32_16x16x32_bf16 v[32:35], v[36:39], v[156:159], v[32:35]
    v_mfma_f32_16x16x32_bf16 v[100:103], v[164:167], v[132:135], v[100:103]
    s_waitcnt lgkmcnt(0)
    v_mfma_f32_16x16x32_bf16 v[40:43], v[136:139], v[104:107], v[40:43]
    ds_read_b128 v[120:123], v18 offset:32768
    v_mfma_f32_16x16x32_bf16 v[44:47], v[140:143], v[104:107], v[44:47]
    ds_read_b64_tr_b16 v[152:153], v19 offset:40960
    v_mfma_f32_16x16x32_bf16 v[56:59], v[136:139], v[108:111], v[56:59]
    ds_read_b64_tr_b16 v[154:155], v19 offset:41984
    v_mfma_f32_16x16x32_bf16 v[48:51], v[144:147], v[104:107], v[48:51]
    ds_read_b128 v[124:127], v18 offset:33792
    v_mfma_f32_16x16x32_bf16 v[60:63], v[140:143], v[108:111], v[60:63]
    ds_read_b64_tr_b16 v[156:157], v20 offset:40960
    v_mfma_f32_16x16x32_bf16 v[72:75], v[136:139], v[112:115], v[72:75]
    ds_read_b64_tr_b16 v[158:159], v20 offset:41984
    v_mfma_f32_16x16x32_bf16 v[52:55], v[148:151], v[104:107], v[52:55]
    ds_read_b128 v[128:131], v18 offset:36864
    v_mfma_f32_16x16x32_bf16 v[64:67], v[144:147], v[108:111], v[64:67]
    ds_read_b64_tr_b16 v[160:161], v21 offset:40960
    v_mfma_f32_16x16x32_bf16 v[76:79], v[140:143], v[112:115], v[76:79]
    ds_read_b64_tr_b16 v[162:163], v21 offset:41984
    v_mfma_f32_16x16x32_bf16 v[88:91], v[136:139], v[116:119], v[88:91]
    ds_read_b128 v[132:135], v18 offset:37888
    v_mfma_f32_16x16x32_bf16 v[68:71], v[148:151], v[108:111], v[68:71]
    ds_read_b64_tr_b16 v[164:165], v22 offset:40960
    v_mfma_f32_16x16x32_bf16 v[80:83], v[144:147], v[112:115], v[80:83]
    ds_read_b64_tr_b16 v[166:167], v22 offset:41984
    v_mfma_f32_16x16x32_bf16 v[92:95], v[140:143], v[116:119], v[92:95]
    v_mfma_f32_16x16x32_bf16 v[28:31], v[36:39], v[136:139], v[28:31]
    v_mfma_f32_16x16x32_bf16 v[84:87], v[148:151], v[112:115], v[84:87]
    v_mfma_f32_16x16x32_bf16 v[96:99], v[144:147], v[116:119], v[96:99]
    v_mfma_f32_16x16x32_bf16 v[32:35], v[36:39], v[140:143], v[32:35]
    v_mfma_f32_16x16x32_bf16 v[100:103], v[148:151], v[116:119], v[100:103]
    s_waitcnt lgkmcnt(0)
    s_add_u32 s38, s38, 1
    s_cmp_eq_u32 s38, 5
    s_cbranch_scc1 P1_TAILQK
    v_xor_b32 v17, 0x10000, v17
    v_xor_b32 v18, 0x10000, v18
    v_xor_b32 v19, 0x10000, v19
    v_xor_b32 v20, 0x10000, v20
    v_xor_b32 v21, 0x10000, v21
    v_xor_b32 v22, 0x10000, v22
    s_barrier
    v_mfma_f32_16x16x32_bf16 v[40:43], v[152:155], v[120:123], v[40:43]
    ds_read_b128 v[104:107], v17 offset:0
    v_mfma_f32_16x16x32_bf16 v[44:47], v[156:159], v[120:123], v[44:47]
    ds_read_b64_tr_b16 v[136:137], v19 offset:0
    v_mfma_f32_16x16x32_bf16 v[56:59], v[152:155], v[124:127], v[56:59]
    ds_read_b64_tr_b16 v[138:139], v19 offset:1024
    v_mfma_f32_16x16x32_bf16 v[48:51], v[160:163], v[120:123], v[48:51]
    ds_read_b128 v[108:111], v17 offset:1024
    v_mfma_f32_16x16x32_bf16 v[60:63], v[156:159], v[124:127], v[60:63]
    ds_read_b64_tr_b16 v[140:141], v20 offset:0
    v_mfma_f32_16x16x32_bf16 v[72:75], v[152:155], v[128:131], v[72:75]
    ds_read_b64_tr_b16 v[142:143], v20 offset:1024
    v_mfma_f32_16x16x32_bf16 v[52:55], v[164:167], v[120:123], v[52:55]
    ds_read_b128 v[112:115], v17 offset:4096
    v_mfma_f32_16x16x32_bf16 v[64:67], v[160:163], v[124:127], v[64:67]
    ds_read_b64_tr_b16 v[144:145], v21 offset:0
    v_mfma_f32_16x16x32_bf16 v[76:79], v[156:159], v[128:131], v[76:79]
    ds_read_b64_tr_b16 v[146:147], v21 offset:1024
    v_mfma_f32_16x16x32_bf16 v[88:91], v[152:155], v[132:135], v[88:91]
    ds_read_b128 v[116:119], v17 offset:5120
    v_mfma_f32_16x16x32_bf16 v[68:71], v[164:167], v[124:127], v[68:71]
    ds_read_b64_tr_b16 v[148:149], v22 offset:0
    v_mfma_f32_16x16x32_bf16 v[80:83], v[160:163], v[128:131], v[80:83]
    ds_read_b64_tr_b16 v[150:151], v22 offset:1024
    v_mfma_f32_16x16x32_bf16 v[92:95], v[156:159], v[132:135], v[92:95]
    v_mfma_f32_16x16x32_bf16 v[28:31], v[36:39], v[152:155], v[28:31]
    v_mfma_f32_16x16x32_bf16 v[84:87], v[164:167], v[128:131], v[84:87]
    v_mfma_f32_16x16x32_bf16 v[96:99], v[160:163], v[132:135], v[96:99]
    v_mfma_f32_16x16x32_bf16 v[32:35], v[36:39], v[156:159], v[32:35]
    v_mfma_f32_16x16x32_bf16 v[100:103], v[164:167], v[132:135], v[100:103]
    s_branch P1_LOOPQK
P1_TAILQK:
    s_lshl_b32 s14, s37, 1
    s_add_u32 s14, s14, s36
    s_lshl_b32 s14, s14, 7
    s_add_u32 s46, s14, 132096
    v_mfma_f32_16x16x32_bf16 v[28:31], v[36:39], v[152:155], v[28:31]
    v_mfma_f32_16x16x32_bf16 v[32:35], v[36:39], v[156:159], v[32:35]
    v_lshl_add_u32 v15, v10, 2, s46
    v_mfma_f32_16x16x32_bf16 v[40:43], v[152:155], v[120:123], v[40:43]
    v_mfma_f32_16x16x32_bf16 v[44:47], v[156:159], v[120:123], v[44:47]
    v_mfma_f32_16x16x32_bf16 v[56:59], v[152:155], v[124:127], v[56:59]
    s_nop 3
    ds_write2_b32 v15, v28, v32 offset0:0 offset1:16
    v_mfma_f32_16x16x32_bf16 v[48:51], v[160:163], v[120:123], v[48:51]
    v_mfma_f32_16x16x32_bf16 v[60:63], v[156:159], v[124:127], v[60:63]
    v_mfma_f32_16x16x32_bf16 v[72:75], v[152:155], v[128:131], v[72:75]
    v_mfma_f32_16x16x32_bf16 v[52:55], v[164:167], v[120:123], v[52:55]
    s_waitcnt lgkmcnt(0)
    s_barrier
    v_mfma_f32_16x16x32_bf16 v[64:67], v[160:163], v[124:127], v[64:67]
    s_lshl_b32 s14, s36, 8
    s_add_u32 s14, s14, 131072
    v_mfma_f32_16x16x32_bf16 v[76:79], v[156:159], v[128:131], v[76:79]
    v_lshl_add_u32 v16, v12, 2, s14
    ds_read2_b32 v[200:201], v16 offset0:0 offset1:128
    v_mfma_f32_16x16x32_bf16 v[88:91], v[152:155], v[132:135], v[88:91]
    ds_read2_b32 v[202:203], v16 offset0:8 offset1:136
    ds_read2_b32 v[204:205], v16 offset0:32 offset1:160
    v_mfma_f32_16x16x32_bf16 v[68:71], v[164:167], v[124:127], v[68:71]
    ds_read2_b32 v[206:207], v16 offset0:40 offset1:168
    v_lshl_add_u32 v13, v11, 4, s46
    v_mfma_f32_16x16x32_bf16 v[80:83], v[160:163], v[128:131], v[80:83]
    v_xor_b32 v14, 128, v13
    ds_read_b128 v[168:171], v13 offset:0
    v_mfma_f32_16x16x32_bf16 v[92:95], v[156:159], v[132:135], v[92:95]
    ds_read_b128 v[172:175], v13 offset:64
    ds_read_b128 v[176:179], v14 offset:0
    v_mfma_f32_16x16x32_bf16 v[84:87], v[164:167], v[128:131], v[84:87]
    ds_read_b128 v[180:183], v14 offset:64
    v_mfma_f32_16x16x32_bf16 v[96:99], v[160:163], v[132:135], v[96:99]
    v_mfma_f32_16x16x32_bf16 v[100:103], v[164:167], v[132:135], v[100:103]
    s_cmp_ge_u32 s21, 5
    s_cselect_b32 s14, 1.0, 0x3ea52b5c
    s_waitcnt lgkmcnt(2)
    v_mul_f32 v201, s14, v201
    v_mul_f32 v203, s14, v203
    v_mul_f32 v205, s14, v205
    v_mul_f32 v207, s14, v207
    v_pk_fma_f32 v[40:41], v[200:201], v[168:169], v[40:41] op_sel_hi:[0,1,1]
    v_pk_fma_f32 v[42:43], v[200:201], v[170:171], v[42:43] op_sel_hi:[0,1,1]
    v_pk_fma_f32 v[44:45], v[200:201], v[172:173], v[44:45] op_sel_hi:[0,1,1]
    v_pk_fma_f32 v[46:47], v[200:201], v[174:175], v[46:47] op_sel_hi:[0,1,1]
    v_pk_mul_f32 v[40:41], v[200:201], v[40:41] op_sel:[1,0] op_sel_hi:[1,1]
    v_pk_mul_f32 v[42:43], v[200:201], v[42:43] op_sel:[1,0] op_sel_hi:[1,1]
    v_pk_mul_f32 v[44:45], v[200:201], v[44:45] op_sel:[1,0] op_sel_hi:[1,1]
    v_pk_mul_f32 v[46:47], v[200:201], v[46:47] op_sel:[1,0] op_sel_hi:[1,1]
    v_cvt_pk_bf16_f32 v208, v40, v41
    v_cvt_pk_bf16_f32 v209, v42, v43
    v_cvt_pk_bf16_f32 v210, v44, v45
    v_cvt_pk_bf16_f32 v211, v46, v47
    buffer_store_dwordx4 v[208:211], v23, s[60:63], 0 offen offset:0 sc1
    v_pk_fma_f32 v[56:57], v[202:203], v[168:169], v[56:57] op_sel_hi:[0,1,1]
    v_pk_fma_f32 v[58:59], v[202:203], v[170:171], v[58:59] op_sel_hi:[0,1,1]
    v_pk_fma_f32 v[60:61], v[202:203], v[172:173], v[60:61] op_sel_hi:[0,1,1]
    v_pk_fma_f32 v[62:63], v[202:203], v[174:175], v[62:63] op_sel_hi:[0,1,1]
    v_pk_mul_f32 v[56:57], v[202:203], v[56:57] op_sel:[1,0] op_sel_hi:[1,1]
    v_pk_mul_f32 v[58:59], v[202:203], v[58:59] op_sel:[1,0] op_sel_hi:[1,1]
    v_pk_mul_f32 v[60:61], v[202:203], v[60:61] op_sel:[1,0] op_sel_hi:[1,1]
    v_pk_mul_f32 v[62:63], v[202:203], v[62:63] op_sel:[1,0] op_sel_hi:[1,1]
    v_cvt_pk_bf16_f32 v212, v56, v57
    v_cvt_pk_bf16_f32 v213, v58, v59
    v_cvt_pk_bf16_f32 v214, v60, v61
    v_cvt_pk_bf16_f32 v215, v62, v63
    buffer_store_dwordx4 v[212:215], v23, s[60:63], 0 offen offset:128 sc1
    v_pk_fma_f32 v[72:73], v[204:205], v[168:169], v[72:73] op_sel_hi:[0,1,1]
    v_pk_fma_f32 v[74:75], v[204:205], v[170:171], v[74:75] op_sel_hi:[0,1,1]
    v_pk_fma_f32 v[76:77], v[204:205], v[172:173], v[76:77] op_sel_hi:[0,1,1]
    v_pk_fma_f32 v[78:79], v[204:205], v[174:175], v[78:79] op_sel_hi:[0,1,1]
    v_pk_mul_f32 v[72:73], v[204:205], v[72:73] op_sel:[1,0] op_sel_hi:[1,1]
    v_pk_mul_f32 v[74:75], v[204:205], v[74:75] op_sel:[1,0] op_sel_hi:[1,1]
    v_pk_mul_f32 v[76:77], v[204:205], v[76:77] op_sel:[1,0] op_sel_hi:[1,1]
    v_pk_mul_f32 v[78:79], v[204:205], v[78:79] op_sel:[1,0] op_sel_hi:[1,1]
    v_cvt_pk_bf16_f32 v208, v72, v73
    v_cvt_pk_bf16_f32 v209, v74, v75
    v_cvt_pk_bf16_f32 v210, v76, v77
    v_cvt_pk_bf16_f32 v211, v78, v79
    buffer_store_dwordx4 v[208:211], v25, s[60:63], 0 offen offset:0 sc1
    v_pk_fma_f32 v[88:89], v[206:207], v[168:169], v[88:89] op_sel_hi:[0,1,1]
    v_pk_fma_f32 v[90:91], v[206:207], v[170:171], v[90:91] op_sel_hi:[0,1,1]
    v_pk_fma_f32 v[92:93], v[206:207], v[172:173], v[92:93] op_sel_hi:[0,1,1]
    v_pk_fma_f32 v[94:95], v[206:207], v[174:175], v[94:95] op_sel_hi:[0,1,1]
    v_pk_mul_f32 v[88:89], v[206:207], v[88:89] op_sel:[1,0] op_sel_hi:[1,1]
    v_pk_mul_f32 v[90:91], v[206:207], v[90:91] op_sel:[1,0] op_sel_hi:[1,1]
    v_pk_mul_f32 v[92:93], v[206:207], v[92:93] op_sel:[1,0] op_sel_hi:[1,1]
    v_pk_mul_f32 v[94:95], v[206:207], v[94:95] op_sel:[1,0] op_sel_hi:[1,1]
    v_cvt_pk_bf16_f32 v212, v88, v89
    v_cvt_pk_bf16_f32 v213, v90, v91
    v_cvt_pk_bf16_f32 v214, v92, v93
    v_cvt_pk_bf16_f32 v215, v94, v95
    buffer_store_dwordx4 v[212:215], v25, s[60:63], 0 offen offset:128 sc1
    s_waitcnt lgkmcnt(0)
    v_pk_fma_f32 v[48:49], v[200:201], v[176:177], v[48:49] op_sel_hi:[0,1,1]
    v_pk_fma_f32 v[50:51], v[200:201], v[178:179], v[50:51] op_sel_hi:[0,1,1]
    v_pk_fma_f32 v[52:53], v[200:201], v[180:181], v[52:53] op_sel_hi:[0,1,1]
    v_pk_fma_f32 v[54:55], v[200:201], v[182:183], v[54:55] op_sel_hi:[0,1,1]
    v_pk_mul_f32 v[48:49], v[200:201], v[48:49] op_sel:[1,0] op_sel_hi:[1,1]
    v_pk_mul_f32 v[50:51], v[200:201], v[50:51] op_sel:[1,0] op_sel_hi:[1,1]
    v_pk_mul_f32 v[52:53], v[200:201], v[52:53] op_sel:[1,0] op_sel_hi:[1,1]
    v_pk_mul_f32 v[54:55], v[200:201], v[54:55] op_sel:[1,0] op_sel_hi:[1,1]
    v_cvt_pk_bf16_f32 v208, v48, v49
    v_cvt_pk_bf16_f32 v209, v50, v51
    v_cvt_pk_bf16_f32 v210, v52, v53
    v_cvt_pk_bf16_f32 v211, v54, v55
    buffer_store_dwordx4 v[208:211], v24, s[60:63], 0 offen offset:0 sc1
    v_pk_fma_f32 v[64:65], v[202:203], v[176:177], v[64:65] op_sel_hi:[0,1,1]
    v_pk_fma_f32 v[66:67], v[202:203], v[178:179], v[66:67] op_sel_hi:[0,1,1]
    v_pk_fma_f32 v[68:69], v[202:203], v[180:181], v[68:69] op_sel_hi:[0,1,1]
    v_pk_fma_f32 v[70:71], v[202:203], v[182:183], v[70:71] op_sel_hi:[0,1,1]
    v_pk_mul_f32 v[64:65], v[202:203], v[64:65] op_sel:[1,0] op_sel_hi:[1,1]
    v_pk_mul_f32 v[66:67], v[202:203], v[66:67] op_sel:[1,0] op_sel_hi:[1,1]
    v_pk_mul_f32 v[68:69], v[202:203], v[68:69] op_sel:[1,0] op_sel_hi:[1,1]
    v_pk_mul_f32 v[70:71], v[202:203], v[70:71] op_sel:[1,0] op_sel_hi:[1,1]
    v_cvt_pk_bf16_f32 v212, v64, v65
    v_cvt_pk_bf16_f32 v213, v66, v67
    v_cvt_pk_bf16_f32 v214, v68, v69
    v_cvt_pk_bf16_f32 v215, v70, v71
    buffer_store_dwordx4 v[212:215], v24, s[60:63], 0 offen offset:128 sc1
    v_pk_fma_f32 v[80:81], v[204:205], v[176:177], v[80:81] op_sel_hi:[0,1,1]
    v_pk_fma_f32 v[82:83], v[204:205], v[178:179], v[82:83] op_sel_hi:[0,1,1]
    v_pk_fma_f32 v[84:85], v[204:205], v[180:181], v[84:85] op_sel_hi:[0,1,1]
    v_pk_fma_f32 v[86:87], v[204:205], v[182:183], v[86:87] op_sel_hi:[0,1,1]
    v_pk_mul_f32 v[80:81], v[204:205], v[80:81] op_sel:[1,0] op_sel_hi:[1,1]
    v_pk_mul_f32 v[82:83], v[204:205], v[82:83] op_sel:[1,0] op_sel_hi:[1,1]
    v_pk_mul_f32 v[84:85], v[204:205], v[84:85] op_sel:[1,0] op_sel_hi:[1,1]
    v_pk_mul_f32 v[86:87], v[204:205], v[86:87] op_sel:[1,0] op_sel_hi:[1,1]
    v_cvt_pk_bf16_f32 v208, v80, v81
    v_cvt_pk_bf16_f32 v209, v82, v83
    v_cvt_pk_bf16_f32 v210, v84, v85
    v_cvt_pk_bf16_f32 v211, v86, v87
    buffer_store_dwordx4 v[208:211], v26, s[60:63], 0 offen offset:0 sc1
    v_pk_fma_f32 v[96:97], v[206:207], v[176:177], v[96:97] op_sel_hi:[0,1,1]
    v_pk_fma_f32 v[98:99], v[206:207], v[178:179], v[98:99] op_sel_hi:[0,1,1]
    v_pk_fma_f32 v[100:101], v[206:207], v[180:181], v[100:101] op_sel_hi:[0,1,1]
    v_pk_fma_f32 v[102:103], v[206:207], v[182:183], v[102:103] op_sel_hi:[0,1,1]
    v_pk_mul_f32 v[96:97], v[206:207], v[96:97] op_sel:[1,0] op_sel_hi:[1,1]
    v_pk_mul_f32 v[98:99], v[206:207], v[98:99] op_sel:[1,0] op_sel_hi:[1,1]
    v_pk_mul_f32 v[100:101], v[206:207], v[100:101] op_sel:[1,0] op_sel_hi:[1,1]
    v_pk_mul_f32 v[102:103], v[206:207], v[102:103] op_sel:[1,0] op_sel_hi:[1,1]
    v_cvt_pk_bf16_f32 v212, v96, v97
    v_cvt_pk_bf16_f32 v213, v98, v99
    v_cvt_pk_bf16_f32 v214, v100, v101
    v_cvt_pk_bf16_f32 v215, v102, v103
    buffer_store_dwordx4 v[212:215], v26, s[60:63], 0 offen offset:128 sc1
    s_waitcnt vmcnt(0)
    s_barrier
    s_branch P2_COMP
P1_V:
    v_bfe_u32 v15, v0, 1, 1
    v_xor_b32 v13, v13, v15
    v_lshl_add_u32 v19, v13, 4, v14
    v_and_b32 v15, 1, v0
    v_lshl_add_u32 v19, v15, 3, v19
    v_xor_b32 v20, 32, v19
    v_xor_b32 v21, 64, v19
    v_xor_b32 v22, 96, v19
    s_sub_u32 s14, s21, 10
    s_lshl_b32 s14, s14, 2
    s_lshl_b32 s15, s37, 1
    s_add_u32 s14, s14, s15
    s_add_u32 s14, s14, s36
    s_mov_b32 s16, 147456
    v_lshrrev_b32 v16, 1, v11
    v_mul_u32_u24 v16, 640, v16
    v_and_b32 v15, 1, v11
    v_mul_u32_u24 v15, 320, v15
    v_add_u32 v16, v16, v15
    s_lshl_b32 s15, s14, 5
    s_add_u32 s15, s15, 0
    v_add_u32 v13, s15, v10
    v_mul_u32_u24 v14, 3277, v13
    v_lshrrev_b32 v14, 16, v14
    v_mul_u32_u24 v15, 20, v14
    v_sub_u32 v13, v13, v15
    v_mul_u32_u24 v23, s16, v14
    v_lshl_add_u32 v23, v13, 4, v23
    v_add_u32 v23, v23, v16
    s_lshl_b32 s15, s14, 5
    s_add_u32 s15, s15, 16
    v_add_u32 v13, s15, v10
    v_mul_u32_u24 v14, 3277, v13
    v_lshrrev_b32 v14, 16, v14
    v_mul_u32_u24 v15, 20, v14
    v_sub_u32 v13, v13, v15
    v_mul_u32_u24 v24, s16, v14
    v_lshl_add_u32 v24, v13, 4, v24
    v_add_u32 v24, v24, v16
    s_xor_b32 s14, s14, 1
    s_lshl_b32 s15, s14, 5
    s_add_u32 s15, s15, 0
    v_add_u32 v13, s15, v10
    v_mul_u32_u24 v14, 3277, v13
    v_lshrrev_b32 v14, 16, v14
    v_mul_u32_u24 v15, 20, v14
    v_sub_u32 v13, v13, v15
    v_mul_u32_u24 v25, s16, v14
    v_lshl_add_u32 v25, v13, 4, v25
    v_add_u32 v25, v25, v16
    s_lshl_b32 s15, s14, 5
    s_add_u32 s15, s15, 16
    v_add_u32 v13, s15, v10
    v_mul_u32_u24 v14, 3277, v13
    v_lshrrev_b32 v14, 16, v14
    v_mul_u32_u24 v15, 20, v14
    v_sub_u32 v13, v13, v15
    v_mul_u32_u24 v26, s16, v14
    v_lshl_add_u32 v26, v13, 4, v26
    v_add_u32 v26, v26, v16
    s_mul_i32 s44, s44, 2304
    s_add_u32 s44, s44, 2622464
    s_mul_i32 s45, s45, 2304
    s_add_u32 s45, s45, 2622464
    s_mov_b32 s38, 0
    s_barrier
    ds_read_b128 v[104:107], v17 offset:0
    ds_read_b64_tr_b16 v[136:137], v19 offset:0
    ds_read_b64_tr_b16 v[138:139], v19 offset:1024
    ds_read_b128 v[108:111], v17 offset:1024
    ds_read_b64_tr_b16 v[140:141], v20 offset:0
    ds_read_b64_tr_b16 v[142:143], v20 offset:1024
    ds_read_b128 v[112:115], v17 offset:4096
    ds_read_b64_tr_b16 v[144:145], v21 offset:0
    ds_read_b64_tr_b16 v[146:147], v21 offset:1024
    ds_read_b128 v[116:119], v17 offset:5120
    ds_read_b64_tr_b16 v[148:149], v22 offset:0
    ds_read_b64_tr_b16 v[150:151], v22 offset:1024
P1_LOOPV:
    s_waitcnt lgkmcnt(0)
    v_mfma_f32_16x16x32_bf16 v[40:43], v[104:107], v[136:139], v[40:43]
    ds_read_b128 v[120:123], v18 offset:0
    v_mfma_f32_16x16x32_bf16 v[44:47], v[104:107], v[140:143], v[44:47]
    ds_read_b64_tr_b16 v[152:153], v19 offset:8192
    v_mfma_f32_16x16x32_bf16 v[56:59], v[108:111], v[136:139], v[56:59]
    ds_read_b64_tr_b16 v[154:155], v19 offset:9216
    v_mfma_f32_16x16x32_bf16 v[48:51], v[104:107], v[144:147], v[48:51]
    ds_read_b128 v[124:127], v18 offset:1024
    v_mfma_f32_16x16x32_bf16 v[60:63], v[108:111], v[140:143], v[60:63]
    ds_read_b64_tr_b16 v[156:157], v20 offset:8192
    v_mfma_f32_16x16x32_bf16 v[72:75], v[112:115], v[136:139], v[72:75]
    ds_read_b64_tr_b16 v[158:159], v20 offset:9216
    v_mfma_f32_16x16x32_bf16 v[52:55], v[104:107], v[148:151], v[52:55]
    ds_read_b128 v[128:131], v18 offset:4096
    v_mfma_f32_16x16x32_bf16 v[64:67], v[108:111], v[144:147], v[64:67]
    ds_read_b64_tr_b16 v[160:161], v21 offset:8192
    v_mfma_f32_16x16x32_bf16 v[76:79], v[112:115], v[140:143], v[76:79]
    ds_read_b64_tr_b16 v[162:163], v21 offset:9216
    v_mfma_f32_16x16x32_bf16 v[88:91], v[116:119], v[136:139], v[88:91]
    ds_read_b128 v[132:135], v18 offset:5120
    v_mfma_f32_16x16x32_bf16 v[68:71], v[108:111], v[148:151], v[68:71]
    ds_read_b64_tr_b16 v[164:165], v22 offset:8192
    v_mfma_f32_16x16x32_bf16 v[80:83], v[112:115], v[144:147], v[80:83]
    ds_read_b64_tr_b16 v[166:167], v22 offset:9216
    v_mfma_f32_16x16x32_bf16 v[92:95], v[116:119], v[140:143], v[92:95]
    v_mfma_f32_16x16x32_bf16 v[28:31], v[36:39], v[136:139], v[28:31]
    v_mfma_f32_16x16x32_bf16 v[84:87], v[112:115], v[148:151], v[84:87]
    v_mfma_f32_16x16x32_bf16 v[96:99], v[116:119], v[144:147], v[96:99]
    v_mfma_f32_16x16x32_bf16 v[32:35], v[36:39], v[140:143], v[32:35]
    v_mfma_f32_16x16x32_bf16 v[100:103], v[116:119], v[148:151], v[100:103]
    s_waitcnt lgkmcnt(0)
    s_barrier
    v_mfma_f32_16x16x32_bf16 v[40:43], v[120:123], v[152:155], v[40:43]
    ds_read_b128 v[104:107], v17 offset:32768
    v_mfma_f32_16x16x32_bf16 v[44:47], v[120:123], v[156:159], v[44:47]
    ds_read_b64_tr_b16 v[136:137], v19 offset:32768
    v_mfma_f32_16x16x32_bf16 v[56:59], v[124:127], v[152:155], v[56:59]
    ds_read_b64_tr_b16 v[138:139], v19 offset:33792
    v_mfma_f32_16x16x32_bf16 v[48:51], v[120:123], v[160:163], v[48:51]
    ds_read_b128 v[108:111], v17 offset:33792
    v_mfma_f32_16x16x32_bf16 v[60:63], v[124:127], v[156:159], v[60:63]
    ds_read_b64_tr_b16 v[140:141], v20 offset:32768
    v_mfma_f32_16x16x32_bf16 v[72:75], v[128:131], v[152:155], v[72:75]
    ds_read_b64_tr_b16 v[142:143], v20 offset:33792
    v_mfma_f32_16x16x32_bf16 v[52:55], v[120:123], v[164:167], v[52:55]
    ds_read_b128 v[112:115], v17 offset:36864
    v_mfma_f32_16x16x32_bf16 v[64:67], v[124:127], v[160:163], v[64:67]
    ds_read_b64_tr_b16 v[144:145], v21 offset:32768
    v_mfma_f32_16x16x32_bf16 v[76:79], v[128:131], v[156:159], v[76:79]
    ds_read_b64_tr_b16 v[146:147], v21 offset:33792
    v_mfma_f32_16x16x32_bf16 v[88:91], v[132:135], v[152:155], v[88:91]
    ds_read_b128 v[116:119], v17 offset:37888
    v_mfma_f32_16x16x32_bf16 v[68:71], v[124:127], v[164:167], v[68:71]
    ds_read_b64_tr_b16 v[148:149], v22 offset:32768
    v_mfma_f32_16x16x32_bf16 v[80:83], v[128:131], v[160:163], v[80:83]
    ds_read_b64_tr_b16 v[150:151], v22 offset:33792
    v_mfma_f32_16x16x32_bf16 v[92:95], v[132:135], v[156:159], v[92:95]
    v_mfma_f32_16x16x32_bf16 v[28:31], v[36:39], v[152:155], v[28:31]
    v_mfma_f32_16x16x32_bf16 v[84:87], v[128:131], v[164:167], v[84:87]
    v_mfma_f32_16x16x32_bf16 v[96:99], v[132:135], v[160:163], v[96:99]
    v_mfma_f32_16x16x32_bf16 v[32:35], v[36:39], v[156:159], v[32:35]
    v_mfma_f32_16x16x32_bf16 v[100:103], v[132:135], v[164:167], v[100:103]
    s_waitcnt lgkmcnt(0)
    v_mfma_f32_16x16x32_bf16 v[40:43], v[104:107], v[136:139], v[40:43]
    ds_read_b128 v[120:123], v18 offset:32768
    v_mfma_f32_16x16x32_bf16 v[44:47], v[104:107], v[140:143], v[44:47]
    ds_read_b64_tr_b16 v[152:153], v19 offset:40960
    v_mfma_f32_16x16x32_bf16 v[56:59], v[108:111], v[136:139], v[56:59]
    ds_read_b64_tr_b16 v[154:155], v19 offset:41984
    v_mfma_f32_16x16x32_bf16 v[48:51], v[104:107], v[144:147], v[48:51]
    ds_read_b128 v[124:127], v18 offset:33792
    v_mfma_f32_16x16x32_bf16 v[60:63], v[108:111], v[140:143], v[60:63]
    ds_read_b64_tr_b16 v[156:157], v20 offset:40960
    v_mfma_f32_16x16x32_bf16 v[72:75], v[112:115], v[136:139], v[72:75]
    ds_read_b64_tr_b16 v[158:159], v20 offset:41984
    v_mfma_f32_16x16x32_bf16 v[52:55], v[104:107], v[148:151], v[52:55]
    ds_read_b128 v[128:131], v18 offset:36864
    v_mfma_f32_16x16x32_bf16 v[64:67], v[108:111], v[144:147], v[64:67]
    ds_read_b64_tr_b16 v[160:161], v21 offset:40960
    v_mfma_f32_16x16x32_bf16 v[76:79], v[112:115], v[140:143], v[76:79]
    ds_read_b64_tr_b16 v[162:163], v21 offset:41984
    v_mfma_f32_16x16x32_bf16 v[88:91], v[116:119], v[136:139], v[88:91]
    ds_read_b128 v[132:135], v18 offset:37888
    v_mfma_f32_16x16x32_bf16 v[68:71], v[108:111], v[148:151], v[68:71]
    ds_read_b64_tr_b16 v[164:165], v22 offset:40960
    v_mfma_f32_16x16x32_bf16 v[80:83], v[112:115], v[144:147], v[80:83]
    ds_read_b64_tr_b16 v[166:167], v22 offset:41984
    v_mfma_f32_16x16x32_bf16 v[92:95], v[116:119], v[140:143], v[92:95]
    v_mfma_f32_16x16x32_bf16 v[28:31], v[36:39], v[136:139], v[28:31]
    v_mfma_f32_16x16x32_bf16 v[84:87], v[112:115], v[148:151], v[84:87]
    v_mfma_f32_16x16x32_bf16 v[96:99], v[116:119], v[144:147], v[96:99]
    v_mfma_f32_16x16x32_bf16 v[32:35], v[36:39], v[140:143], v[32:35]
    v_mfma_f32_16x16x32_bf16 v[100:103], v[116:119], v[148:151], v[100:103]
    s_waitcnt lgkmcnt(0)
    s_add_u32 s38, s38, 1
    s_cmp_eq_u32 s38, 5
    s_cbranch_scc1 P1_TAILV
    v_xor_b32 v17, 0x10000, v17
    v_xor_b32 v18, 0x10000, v18
    v_xor_b32 v19, 0x10000, v19
    v_xor_b32 v20, 0x10000, v20
    v_xor_b32 v21, 0x10000, v21
    v_xor_b32 v22, 0x10000, v22
    s_barrier
    v_mfma_f32_16x16x32_bf16 v[40:43], v[120:123], v[152:155], v[40:43]
    ds_read_b128 v[104:107], v17 offset:0
    v_mfma_f32_16x16x32_bf16 v[44:47], v[120:123], v[156:159], v[44:47]
    ds_read_b64_tr_b16 v[136:137], v19 offset:0
    v_mfma_f32_16x16x32_bf16 v[56:59], v[124:127], v[152:155], v[56:59]
    ds_read_b64_tr_b16 v[138:139], v19 offset:1024
    v_mfma_f32_16x16x32_bf16 v[48:51], v[120:123], v[160:163], v[48:51]
    ds_read_b128 v[108:111], v17 offset:1024
    v_mfma_f32_16x16x32_bf16 v[60:63], v[124:127], v[156:159], v[60:63]
    ds_read_b64_tr_b16 v[140:141], v20 offset:0
    v_mfma_f32_16x16x32_bf16 v[72:75], v[128:131], v[152:155], v[72:75]
    ds_read_b64_tr_b16 v[142:143], v20 offset:1024
    v_mfma_f32_16x16x32_bf16 v[52:55], v[120:123], v[164:167], v[52:55]
    ds_read_b128 v[112:115], v17 offset:4096
    v_mfma_f32_16x16x32_bf16 v[64:67], v[124:127], v[160:163], v[64:67]
    ds_read_b64_tr_b16 v[144:145], v21 offset:0
    v_mfma_f32_16x16x32_bf16 v[76:79], v[128:131], v[156:159], v[76:79]
    ds_read_b64_tr_b16 v[146:147], v21 offset:1024
    v_mfma_f32_16x16x32_bf16 v[88:91], v[132:135], v[152:155], v[88:91]
    ds_read_b128 v[116:119], v17 offset:5120
    v_mfma_f32_16x16x32_bf16 v[68:71], v[124:127], v[164:167], v[68:71]
    ds_read_b64_tr_b16 v[148:149], v22 offset:0
    v_mfma_f32_16x16x32_bf16 v[80:83], v[128:131], v[160:163], v[80:83]
    ds_read_b64_tr_b16 v[150:151], v22 offset:1024
    v_mfma_f32_16x16x32_bf16 v[92:95], v[132:135], v[156:159], v[92:95]
    v_mfma_f32_16x16x32_bf16 v[28:31], v[36:39], v[152:155], v[28:31]
    v_mfma_f32_16x16x32_bf16 v[84:87], v[128:131], v[164:167], v[84:87]
    v_mfma_f32_16x16x32_bf16 v[96:99], v[132:135], v[160:163], v[96:99]
    v_mfma_f32_16x16x32_bf16 v[32:35], v[36:39], v[156:159], v[32:35]
    v_mfma_f32_16x16x32_bf16 v[100:103], v[132:135], v[164:167], v[100:103]
    s_branch P1_LOOPV
P1_TAILV:
    s_lshl_b32 s14, s37, 1
    s_add_u32 s14, s14, s36
    s_lshl_b32 s14, s14, 7
    s_add_u32 s46, s14, 132096
    v_mfma_f32_16x16x32_bf16 v[28:31], v[36:39], v[152:155], v[28:31]
    v_mfma_f32_16x16x32_bf16 v[32:35], v[36:39], v[156:159], v[32:35]
    v_lshl_add_u32 v15, v10, 2, s46
    v_mfma_f32_16x16x32_bf16 v[40:43], v[120:123], v[152:155], v[40:43]
    v_mfma_f32_16x16x32_bf16 v[44:47], v[120:123], v[156:159], v[44:47]
    v_mfma_f32_16x16x32_bf16 v[56:59], v[124:127], v[152:155], v[56:59]
    s_nop 3
    ds_write2_b32 v15, v28, v32 offset0:0 offset1:16
    v_mfma_f32_16x16x32_bf16 v[48:51], v[120:123], v[160:163], v[48:51]
    v_mfma_f32_16x16x32_bf16 v[60:63], v[124:127], v[156:159], v[60:63]
    v_mfma_f32_16x16x32_bf16 v[72:75], v[128:131], v[152:155], v[72:75]
    v_mfma_f32_16x16x32_bf16 v[52:55], v[120:123], v[164:167], v[52:55]
    s_waitcnt lgkmcnt(0)
    s_barrier
    v_mfma_f32_16x16x32_bf16 v[64:67], v[124:127], v[160:163], v[64:67]
    v_xor_b32 v14, 128, v15
    v_mov_b32 v200, v28
    v_mov_b32 v202, v32
    v_mfma_f32_16x16x32_bf16 v[76:79], v[128:131], v[156:159], v[76:79]
    ds_read_b32 v204, v14
    ds_read_b32 v206, v14 offset:64
    s_lshl_b32 s14, s36, 8
    v_mfma_f32_16x16x32_bf16 v[88:91], v[132:135], v[152:155], v[88:91]
    s_add_u32 s14, s14, 131072
    v_lshrrev_b32 v13, 1, v11
    v_lshlrev_b32 v13, 6, v13
    v_mfma_f32_16x16x32_bf16 v[68:71], v[124:127], v[164:167], v[68:71]
    v_and_b32 v16, 1, v11
    v_lshl_add_u32 v13, v16, 4, v13
    v_add_u32 v13, s14, v13
    v_mfma_f32_16x16x32_bf16 v[80:83], v[128:131], v[160:163], v[80:83]
    ds_read_b128 v[168:171], v13 offset:0
    ds_read_b128 v[172:175], v13 offset:512
    ds_read_b128 v[176:179], v13 offset:32
    v_mfma_f32_16x16x32_bf16 v[92:95], v[132:135], v[156:159], v[92:95]
    ds_read_b128 v[180:183], v13 offset:544
    ds_read_b128 v[184:187], v13 offset:128
    ds_read_b128 v[188:191], v13 offset:640
    v_mfma_f32_16x16x32_bf16 v[84:87], v[128:131], v[164:167], v[84:87]
    ds_read_b128 v[192:195], v13 offset:160
    ds_read_b128 v[196:199], v13 offset:672
    v_mfma_f32_16x16x32_bf16 v[96:99], v[132:135], v[160:163], v[96:99]
    v_mfma_f32_16x16x32_bf16 v[100:103], v[132:135], v[164:167], v[100:103]
    s_waitcnt lgkmcnt(4)
    v_pk_fma_f32 v[40:41], v[200:201], v[168:169], v[40:41] op_sel_hi:[0,1,1]
    v_pk_fma_f32 v[42:43], v[200:201], v[170:171], v[42:43] op_sel_hi:[0,1,1]
    v_pk_fma_f32 v[56:57], v[200:201], v[176:177], v[56:57] op_sel_hi:[0,1,1]
    v_pk_fma_f32 v[58:59], v[200:201], v[178:179], v[58:59] op_sel_hi:[0,1,1]
    v_pk_mul_f32 v[40:41], v[172:173], v[40:41]
    v_pk_mul_f32 v[42:43], v[174:175], v[42:43]
    v_pk_mul_f32 v[56:57], v[180:181], v[56:57]
    v_pk_mul_f32 v[58:59], v[182:183], v[58:59]
    v_cvt_pk_bf16_f32 v208, v40, v41
    v_cvt_pk_bf16_f32 v209, v42, v43
    v_cvt_pk_bf16_f32 v210, v56, v57
    v_cvt_pk_bf16_f32 v211, v58, v59
    buffer_store_dwordx4 v[208:211], v23, s[60:63], s44 offen sc1
    v_pk_fma_f32 v[44:45], v[202:203], v[168:169], v[44:45] op_sel_hi:[0,1,1]
    v_pk_fma_f32 v[46:47], v[202:203], v[170:171], v[46:47] op_sel_hi:[0,1,1]
    v_pk_fma_f32 v[60:61], v[202:203], v[176:177], v[60:61] op_sel_hi:[0,1,1]
    v_pk_fma_f32 v[62:63], v[202:203], v[178:179], v[62:63] op_sel_hi:[0,1,1]
    v_pk_mul_f32 v[44:45], v[172:173], v[44:45]
    v_pk_mul_f32 v[46:47], v[174:175], v[46:47]
    v_pk_mul_f32 v[60:61], v[180:181], v[60:61]
    v_pk_mul_f32 v[62:63], v[182:183], v[62:63]
    v_cvt_pk_bf16_f32 v212, v44, v45
    v_cvt_pk_bf16_f32 v213, v46, v47
    v_cvt_pk_bf16_f32 v214, v60, v61
    v_cvt_pk_bf16_f32 v215, v62, v63
    buffer_store_dwordx4 v[212:215], v24, s[60:63], s44 offen sc1
    v_pk_fma_f32 v[48:49], v[204:205], v[168:169], v[48:49] op_sel_hi:[0,1,1]
    v_pk_fma_f32 v[50:51], v[204:205], v[170:171], v[50:51] op_sel_hi:[0,1,1]
    v_pk_fma_f32 v[64:65], v[204:205], v[176:177], v[64:65] op_sel_hi:[0,1,1]
    v_pk_fma_f32 v[66:67], v[204:205], v[178:179], v[66:67] op_sel_hi:[0,1,1]
    v_pk_mul_f32 v[48:49], v[172:173], v[48:49]
    v_pk_mul_f32 v[50:51], v[174:175], v[50:51]
    v_pk_mul_f32 v[64:65], v[180:181], v[64:65]
    v_pk_mul_f32 v[66:67], v[182:183], v[66:67]
    v_cvt_pk_bf16_f32 v208, v48, v49
    v_cvt_pk_bf16_f32 v209, v50, v51
    v_cvt_pk_bf16_f32 v210, v64, v65
    v_cvt_pk_bf16_f32 v211, v66, v67
    buffer_store_dwordx4 v[208:211], v25, s[60:63], s44 offen sc1
    v_pk_fma_f32 v[52:53], v[206:207], v[168:169], v[52:53] op_sel_hi:[0,1,1]
    v_pk_fma_f32 v[54:55], v[206:207], v[170:171], v[54:55] op_sel_hi:[0,1,1]
    v_pk_fma_f32 v[68:69], v[206:207], v[176:177], v[68:69] op_sel_hi:[0,1,1]
    v_pk_fma_f32 v[70:71], v[206:207], v[178:179], v[70:71] op_sel_hi:[0,1,1]
    v_pk_mul_f32 v[52:53], v[172:173], v[52:53]
    v_pk_mul_f32 v[54:55], v[174:175], v[54:55]
    v_pk_mul_f32 v[68:69], v[180:181], v[68:69]
    v_pk_mul_f32 v[70:71], v[182:183], v[70:71]
    v_cvt_pk_bf16_f32 v212, v52, v53
    v_cvt_pk_bf16_f32 v213, v54, v55
    v_cvt_pk_bf16_f32 v214, v68, v69
    v_cvt_pk_bf16_f32 v215, v70, v71
    buffer_store_dwordx4 v[212:215], v26, s[60:63], s44 offen sc1
    s_waitcnt lgkmcnt(0)
    v_pk_fma_f32 v[72:73], v[200:201], v[184:185], v[72:73] op_sel_hi:[0,1,1]
    v_pk_fma_f32 v[74:75], v[200:201], v[186:187], v[74:75] op_sel_hi:[0,1,1]
    v_pk_fma_f32 v[88:89], v[200:201], v[192:193], v[88:89] op_sel_hi:[0,1,1]
    v_pk_fma_f32 v[90:91], v[200:201], v[194:195], v[90:91] op_sel_hi:[0,1,1]
    v_pk_mul_f32 v[72:73], v[188:189], v[72:73]
    v_pk_mul_f32 v[74:75], v[190:191], v[74:75]
    v_pk_mul_f32 v[88:89], v[196:197], v[88:89]
    v_pk_mul_f32 v[90:91], v[198:199], v[90:91]
    v_cvt_pk_bf16_f32 v208, v72, v73
    v_cvt_pk_bf16_f32 v209, v74, v75
    v_cvt_pk_bf16_f32 v210, v88, v89
    v_cvt_pk_bf16_f32 v211, v90, v91
    buffer_store_dwordx4 v[208:211], v23, s[60:63], s45 offen sc1
    v_pk_fma_f32 v[76:77], v[202:203], v[184:185], v[76:77] op_sel_hi:[0,1,1]
    v_pk_fma_f32 v[78:79], v[202:203], v[186:187], v[78:79] op_sel_hi:[0,1,1]
    v_pk_fma_f32 v[92:93], v[202:203], v[192:193], v[92:93] op_sel_hi:[0,1,1]
    v_pk_fma_f32 v[94:95], v[202:203], v[194:195], v[94:95] op_sel_hi:[0,1,1]
    v_pk_mul_f32 v[76:77], v[188:189], v[76:77]
    v_pk_mul_f32 v[78:79], v[190:191], v[78:79]
    v_pk_mul_f32 v[92:93], v[196:197], v[92:93]
    v_pk_mul_f32 v[94:95], v[198:199], v[94:95]
    v_cvt_pk_bf16_f32 v212, v76, v77
    v_cvt_pk_bf16_f32 v213, v78, v79
    v_cvt_pk_bf16_f32 v214, v92, v93
    v_cvt_pk_bf16_f32 v215, v94, v95
    buffer_store_dwordx4 v[212:215], v24, s[60:63], s45 offen sc1
    v_pk_fma_f32 v[80:81], v[204:205], v[184:185], v[80:81] op_sel_hi:[0,1,1]
    v_pk_fma_f32 v[82:83], v[204:205], v[186:187], v[82:83] op_sel_hi:[0,1,1]
    v_pk_fma_f32 v[96:97], v[204:205], v[192:193], v[96:97] op_sel_hi:[0,1,1]
    v_pk_fma_f32 v[98:99], v[204:205], v[194:195], v[98:99] op_sel_hi:[0,1,1]
    v_pk_mul_f32 v[80:81], v[188:189], v[80:81]
    v_pk_mul_f32 v[82:83], v[190:191], v[82:83]
    v_pk_mul_f32 v[96:97], v[196:197], v[96:97]
    v_pk_mul_f32 v[98:99], v[198:199], v[98:99]
    v_cvt_pk_bf16_f32 v208, v80, v81
    v_cvt_pk_bf16_f32 v209, v82, v83
    v_cvt_pk_bf16_f32 v210, v96, v97
    v_cvt_pk_bf16_f32 v211, v98, v99
    buffer_store_dwordx4 v[208:211], v25, s[60:63], s45 offen sc1
    v_pk_fma_f32 v[84:85], v[206:207], v[184:185], v[84:85] op_sel_hi:[0,1,1]
    v_pk_fma_f32 v[86:87], v[206:207], v[186:187], v[86:87] op_sel_hi:[0,1,1]
    v_pk_fma_f32 v[100:101], v[206:207], v[192:193], v[100:101] op_sel_hi:[0,1,1]
    v_pk_fma_f32 v[102:103], v[206:207], v[194:195], v[102:103] op_sel_hi:[0,1,1]
    v_pk_mul_f32 v[84:85], v[188:189], v[84:85]
    v_pk_mul_f32 v[86:87], v[190:191], v[86:87]
    v_pk_mul_f32 v[100:101], v[196:197], v[100:101]
    v_pk_mul_f32 v[102:103], v[198:199], v[102:103]
    v_cvt_pk_bf16_f32 v212, v84, v85
    v_cvt_pk_bf16_f32 v213, v86, v87
    v_cvt_pk_bf16_f32 v214, v100, v101
    v_cvt_pk_bf16_f32 v215, v102, v103
    buffer_store_dwordx4 v[212:215], v26, s[60:63], s45 offen sc1
    s_waitcnt vmcnt(0)
    s_barrier
    s_branch P2_COMP
P1_AUX:
    s_mov_b32 s40, 1065369472
    v_and_b32 v2, 7, v0
    v_lshlrev_b32 v7, 4, v2
    v_lshrrev_b32 v3, 3, v0
    v_mul_u32_u24 v6, 1280, v3
    v_add_u32 v6, v6, v7
    s_lshl_b32 s14, s20, 3
    s_add_u32 s14, s14, s3
    s_mul_i32 s41, s14, 20480
    s_add_u32 s42, s41, 10240
    v_mov_b32 v140, 0
    v_mov_b32 v141, 0
    v_mov_b32 v142, 0
    v_mov_b32 v143, 0
    s_lshl_b32 s14, s3, 10
    v_add_u32 v4, s14, v1
    v_cmp_gt_u32 vcc, 2560, v4
    v_mov_b32 v5, 0x7ffffff0
    s_nop 0
    v_cndmask_b32 v4, v5, v4, vcc
    v_lshlrev_b32 v5, 8, v0
    s_waitcnt lgkmcnt(0)
    s_mov_b32 s24, s64
    s_mov_b32 s25, s65
    s_mov_b32 s26, 2621440
    s_mov_b32 s27, 0x00020000
    s_mov_b32 s60, s84
    s_mov_b32 s61, s85
    s_mov_b32 s62, 11829248
    s_mov_b32 s63, 0x00020000
    s_mov_b32 s28, s72
    s_mov_b32 s29, s73
    s_mov_b32 s30, 1280
    s_mov_b32 s31, 0x00020000
    s_mov_b32 s32, s82
    s_mov_b32 s33, s83
    s_mov_b32 s34, 256
    s_mov_b32 s35, 0x00020000
    s_mul_i32 s14, s20, 26624
    s_add_u32 s14, s14, 10551296
    s_cmp_eq_u32 s3, 0
    s_cselect_b32 s14, s14, 0x7ff00000
    s_add_u32 s15, s14, 16384
    buffer_store_dword v140, v5, s[60:63], s14 offen sc1
    s_mov_b32 exec_hi, 0xff
    buffer_store_dword v140, v5, s[60:63], s15 offen sc1
    s_lshl_b32 s15, s20, 8
    s_add_u32 s15, s15, 10977280
    s_cmp_eq_u32 s3, 0
    s_cselect_b32 s15, s15, 0x7ff00000
    s_mov_b64 exec, 1
    buffer_store_dword v140, v5, s[60:63], s15 offen sc1
    s_mov_b64 exec, -1
    buffer_load_dwordx4 v[20:23], v6, s[24:27], s41 offen offset:0
    buffer_load_dwordx4 v[24:27], v6, s[24:27], s41 offen offset:128
    buffer_load_dwordx4 v[28:31], v6, s[24:27], s41 offen offset:256
    buffer_load_dwordx4 v[32:35], v6, s[24:27], s41 offen offset:384
    buffer_load_dwordx4 v[36:39], v6, s[24:27], s41 offen offset:512
    buffer_load_dwordx4 v[40:43], v6, s[24:27], s41 offen offset:640
    buffer_load_dwordx4 v[44:47], v6, s[24:27], s41 offen offset:768
    buffer_load_dwordx4 v[48:51], v6, s[24:27], s41 offen offset:896
    buffer_load_dwordx4 v[52:55], v6, s[24:27], s41 offen offset:1024
    buffer_load_dwordx4 v[56:59], v6, s[24:27], s41 offen offset:1152
    s_and_b32 s14, s3, 1
    s_lshl_b32 m0, s14, 10
    s_mul_i32 s14, s20, 2560
    buffer_load_dwordx4 v1, s[28:31], m0 offen lds
    s_add_u32 s14, s14, 10506240
    buffer_store_dwordx4 v[140:143], v4, s[60:63], s14 offen sc1
    buffer_load_dwordx4 v[60:63], v6, s[24:27], s42 offen offset:0
    buffer_load_dwordx4 v[64:67], v6, s[24:27], s42 offen offset:128
    buffer_load_dwordx4 v[68:71], v6, s[24:27], s42 offen offset:256
    buffer_load_dwordx4 v[72:75], v6, s[24:27], s42 offen offset:384
    buffer_load_dwordx4 v[76:79], v6, s[24:27], s42 offen offset:512
    buffer_load_dwordx4 v[80:83], v6, s[24:27], s42 offen offset:640
    buffer_load_dwordx4 v[84:87], v6, s[24:27], s42 offen offset:768
    buffer_load_dwordx4 v[88:91], v6, s[24:27], s42 offen offset:896
    buffer_load_dwordx4 v[92:95], v6, s[24:27], s42 offen offset:1024
    buffer_load_dwordx4 v[96:99], v6, s[24:27], s42 offen offset:1152
    v_mov_b32 v8, 0
    v_mov_b32 v9, 0
    v_mov_b32 v10, 0
    v_mov_b32 v11, 0
    v_mov_b32 v12, 0
    v_mov_b32 v13, 0
    v_mov_b32 v14, 0
    s_waitcnt vmcnt(20)
    s_cmp_eq_u32 s3, 0
    s_cselect_b32 s14, 64, 0x1000
    v_mov_b32 v141, 1
    s_mov_b64 exec, 1
    buffer_atomic_add v141, off, s[32:35], s14 sc0
    s_mov_b64 exec, -1
    v_dot2c_f32_bf16 v8, s40, v20
    v_dot2c_f32_bf16 v9, v20, v20
    v_dot2c_f32_bf16 v8, s40, v21
    v_dot2c_f32_bf16 v9, v21, v21
    v_dot2c_f32_bf16 v8, s40, v22
    v_dot2c_f32_bf16 v9, v22, v22
    v_dot2c_f32_bf16 v8, s40, v23
    v_dot2c_f32_bf16 v9, v23, v23
    v_dot2c_f32_bf16 v8, s40, v24
    v_dot2c_f32_bf16 v9, v24, v24
    v_dot2c_f32_bf16 v8, s40, v25
    v_dot2c_f32_bf16 v9, v25, v25
    v_dot2c_f32_bf16 v8, s40, v26
    v_dot2c_f32_bf16 v9, v26, v26
    v_dot2c_f32_bf16 v8, s40, v27
    v_dot2c_f32_bf16 v9, v27, v27
    s_waitcnt vmcnt(19)
    v_dot2c_f32_bf16 v8, s40, v28
    v_dot2c_f32_bf16 v9, v28, v28
    v_dot2c_f32_bf16 v8, s40, v29
    v_dot2c_f32_bf16 v9, v29, v29
    v_dot2c_f32_bf16 v8, s40, v30
    v_dot2c_f32_bf16 v9, v30, v30
    v_dot2c_f32_bf16 v8, s40, v31
    v_dot2c_f32_bf16 v9, v31, v31
    v_dot2c_f32_bf16 v8, s40, v32
    v_dot2c_f32_bf16 v9, v32, v32
    v_dot2c_f32_bf16 v8, s40, v33
    v_dot2c_f32_bf16 v9, v33, v33
    v_dot2c_f32_bf16 v8, s40, v34
    v_dot2c_f32_bf16 v9, v34, v34
    v_dot2c_f32_bf16 v8, s40, v35
    v_dot2c_f32_bf16 v9, v35, v35
    s_waitcnt vmcnt(17)
    v_dot2c_f32_bf16 v8, s40, v36
    v_dot2c_f32_bf16 v9, v36, v36
    v_dot2c_f32_bf16 v8, s40, v37
    v_dot2c_f32_bf16 v9, v37, v37
    v_dot2c_f32_bf16 v8, s40, v38
    v_dot2c_f32_bf16 v9, v38, v38
    v_dot2c_f32_bf16 v8, s40, v39
    v_dot2c_f32_bf16 v9, v39, v39
    v_dot2c_f32_bf16 v8, s40, v40
    v_dot2c_f32_bf16 v9, v40, v40
    v_dot2c_f32_bf16 v8, s40, v41
    v_dot2c_f32_bf16 v9, v41, v41
    v_dot2c_f32_bf16 v8, s40, v42
    v_dot2c_f32_bf16 v9, v42, v42
    v_dot2c_f32_bf16 v8, s40, v43
    v_dot2c_f32_bf16 v9, v43, v43
    s_waitcnt vmcnt(15)
    v_dot2c_f32_bf16 v8, s40, v44
    v_dot2c_f32_bf16 v9, v44, v44
    v_dot2c_f32_bf16 v8, s40, v45
    v_dot2c_f32_bf16 v9, v45, v45
    v_dot2c_f32_bf16 v8, s40, v46
    v_dot2c_f32_bf16 v9, v46, v46
    v_dot2c_f32_bf16 v8, s40, v47
    v_dot2c_f32_bf16 v9, v47, v47
    v_dot2c_f32_bf16 v8, s40, v48
    v_dot2c_f32_bf16 v9, v48, v48
    v_dot2c_f32_bf16 v8, s40, v49
    v_dot2c_f32_bf16 v9, v49, v49
    v_dot2c_f32_bf16 v8, s40, v50
    v_dot2c_f32_bf16 v9, v50, v50
    v_dot2c_f32_bf16 v8, s40, v51
    v_dot2c_f32_bf16 v9, v51, v51
    s_waitcnt vmcnt(13)
    v_dot2c_f32_bf16 v8, s40, v52
    v_dot2c_f32_bf16 v9, v52, v52
    v_dot2c_f32_bf16 v8, s40, v53
    v_dot2c_f32_bf16 v9, v53, v53
    v_dot2c_f32_bf16 v8, s40, v54
    v_dot2c_f32_bf16 v9, v54, v54
    v_dot2c_f32_bf16 v8, s40, v55
    v_dot2c_f32_bf16 v9, v55, v55
    v_dot2c_f32_bf16 v8, s40, v56
    v_dot2c_f32_bf16 v9, v56, v56
    v_dot2c_f32_bf16 v8, s40, v57
    v_dot2c_f32_bf16 v9, v57, v57
    v_dot2c_f32_bf16 v8, s40, v58
    v_dot2c_f32_bf16 v9, v58, v58
    v_dot2c_f32_bf16 v8, s40, v59
    v_dot2c_f32_bf16 v9, v59, v59
    s_waitcnt vmcnt(9)
    v_dot2c_f32_bf16 v11, s40, v60
    v_dot2c_f32_bf16 v12, v60, v60
    v_dot2c_f32_bf16 v11, s40, v61
    v_dot2c_f32_bf16 v12, v61, v61
    v_dot2c_f32_bf16 v11, s40, v62
    v_dot2c_f32_bf16 v12, v62, v62
    v_dot2c_f32_bf16 v11, s40, v63
    v_dot2c_f32_bf16 v12, v63, v63
    v_dot2c_f32_bf16 v11, s40, v64
    v_dot2c_f32_bf16 v12, v64, v64
    v_dot2c_f32_bf16 v11, s40, v65
    v_dot2c_f32_bf16 v12, v65, v65
    v_dot2c_f32_bf16 v11, s40, v66
    v_dot2c_f32_bf16 v12, v66, v66
    v_dot2c_f32_bf16 v11, s40, v67
    v_dot2c_f32_bf16 v12, v67, v67
    s_waitcnt vmcnt(7)
    v_dot2c_f32_bf16 v11, s40, v68
    v_dot2c_f32_bf16 v12, v68, v68
    v_dot2c_f32_bf16 v11, s40, v69
    v_dot2c_f32_bf16 v12, v69, v69
    v_dot2c_f32_bf16 v11, s40, v70
    v_dot2c_f32_bf16 v12, v70, v70
    v_dot2c_f32_bf16 v11, s40, v71
    v_dot2c_f32_bf16 v12, v71, v71
    v_dot2c_f32_bf16 v11, s40, v72
    v_dot2c_f32_bf16 v12, v72, v72
    v_dot2c_f32_bf16 v11, s40, v73
    v_dot2c_f32_bf16 v12, v73, v73
    v_dot2c_f32_bf16 v11, s40, v74
    v_dot2c_f32_bf16 v12, v74, v74
    v_dot2c_f32_bf16 v11, s40, v75
    v_dot2c_f32_bf16 v12, v75, v75
    s_waitcnt vmcnt(5)
    v_dot2c_f32_bf16 v11, s40, v76
    v_dot2c_f32_bf16 v12, v76, v76
    v_dot2c_f32_bf16 v11, s40, v77
    v_dot2c_f32_bf16 v12, v77, v77
    v_dot2c_f32_bf16 v11, s40, v78
    v_dot2c_f32_bf16 v12, v78, v78
    v_dot2c_f32_bf16 v11, s40, v79
    v_dot2c_f32_bf16 v12, v79, v79
    v_dot2c_f32_bf16 v11, s40, v80
    v_dot2c_f32_bf16 v12, v80, v80
    v_dot2c_f32_bf16 v11, s40, v81
    v_dot2c_f32_bf16 v12, v81, v81
    v_dot2c_f32_bf16 v11, s40, v82
    v_dot2c_f32_bf16 v12, v82, v82
    v_dot2c_f32_bf16 v11, s40, v83
    v_dot2c_f32_bf16 v12, v83, v83
    s_waitcnt vmcnt(3)
    v_dot2c_f32_bf16 v11, s40, v84
    v_dot2c_f32_bf16 v12, v84, v84
    v_dot2c_f32_bf16 v11, s40, v85
    v_dot2c_f32_bf16 v12, v85, v85
    v_dot2c_f32_bf16 v11, s40, v86
    v_dot2c_f32_bf16 v12, v86, v86
    v_dot2c_f32_bf16 v11, s40, v87
    v_dot2c_f32_bf16 v12, v87, v87
    v_dot2c_f32_bf16 v11, s40, v88
    v_dot2c_f32_bf16 v12, v88, v88
    v_dot2c_f32_bf16 v11, s40, v89
    v_dot2c_f32_bf16 v12, v89, v89
    v_dot2c_f32_bf16 v11, s40, v90
    v_dot2c_f32_bf16 v12, v90, v90
    v_dot2c_f32_bf16 v11, s40, v91
    v_dot2c_f32_bf16 v12, v91, v91
    s_waitcnt vmcnt(1)
    v_dot2c_f32_bf16 v11, s40, v92
    v_dot2c_f32_bf16 v12, v92, v92
    v_dot2c_f32_bf16 v11, s40, v93
    v_dot2c_f32_bf16 v12, v93, v93
    v_dot2c_f32_bf16 v11, s40, v94
    v_dot2c_f32_bf16 v12, v94, v94
    v_dot2c_f32_bf16 v11, s40, v95
    v_dot2c_f32_bf16 v12, v95, v95
    v_dot2c_f32_bf16 v11, s40, v96
    v_dot2c_f32_bf16 v12, v96, v96
    v_dot2c_f32_bf16 v11, s40, v97
    v_dot2c_f32_bf16 v12, v97, v97
    v_dot2c_f32_bf16 v11, s40, v98
    v_dot2c_f32_bf16 v12, v98, v98
    v_dot2c_f32_bf16 v11, s40, v99
    v_dot2c_f32_bf16 v12, v99, v99
    s_waitcnt vmcnt(0)
    v_readfirstlane_b32 s14, v141
    s_lshl_b32 s15, s3, 8
    s_or_b32 s14, s14, s15
    s_cmp_lg_u32 s14, 15
    s_cbranch_scc1 P1_AUX1
    v_mov_b32 v2, 1
    s_mov_b64 exec, 1
    buffer_store_dword v2, off, s[32:35], 0 offset:192 sc1
    s_mov_b64 exec, -1
P1_AUX1:
    v_add_f32_dpp v8, v8, v8 quad_perm:[1,0,3,2] row_mask:0xf bank_mask:0xf
    v_add_f32_dpp v9, v9, v9 quad_perm:[1,0,3,2] row_mask:0xf bank_mask:0xf
    v_add_f32_dpp v11, v11, v11 quad_perm:[1,0,3,2] row_mask:0xf bank_mask:0xf
    v_add_f32_dpp v12, v12, v12 quad_perm:[1,0,3,2] row_mask:0xf bank_mask:0xf
    v_add_f32_dpp v8, v8, v8 quad_perm:[2,3,0,1] row_mask:0xf bank_mask:0xf
    v_add_f32_dpp v9, v9, v9 quad_perm:[2,3,0,1] row_mask:0xf bank_mask:0xf
    v_add_f32_dpp v11, v11, v11 quad_perm:[2,3,0,1] row_mask:0xf bank_mask:0xf
    v_add_f32_dpp v12, v12, v12 quad_perm:[2,3,0,1] row_mask:0xf bank_mask:0xf
    v_add_f32_dpp v8, v8, v8 row_half_mirror row_mask:0xf bank_mask:0xf
    v_add_f32_dpp v9, v9, v9 row_half_mirror row_mask:0xf bank_mask:0xf
    v_add_f32_dpp v11, v11, v11 row_half_mirror row_mask:0xf bank_mask:0xf
    v_add_f32_dpp v12, v12, v12 row_half_mirror row_mask:0xf bank_mask:0xf
    v_and_b32 v4, 1, v0
    v_cmp_eq_u32 vcc, 1, v4
    v_lshrrev_b32 v5, 3, v0
    s_nop 0
    v_cndmask_b32 v8, v8, v11, vcc
    v_cndmask_b32 v9, v9, v12, vcc
    v_lshl_add_u32 v4, v4, 3, v5
    s_lshl_b32 s15, s3, 4
    v_add_u32 v4, s15, v4
    v_mul_f32 v2, 0x3acccccd, v8
    v_mul_f32 v3, 0x3acccccd, v9
    v_fma_f32 v3, -v2, v2, v3
    v_max_f32 v3, 0, v3
    v_cvt_pk_bf16_f32 v2, v2, v3
    v_lshlrev_b32 v16, 16, v2
    v_and_b32 v3, 0xffff0000, v2
    v_add_f32 v3, 0x3727c5ac, v3
    v_cvt_pk_bf16_f32 v3, v3, v3
    v_and_b32 v3, 0xffff0000, v3
    v_sqrt_f32 v3, v3
    s_nop 0
    v_cvt_pk_bf16_f32 v3, v3, v3
    v_and_b32 v3, 0xffff0000, v3
    v_rcp_f32 v17, v3
    v_lshlrev_b32 v5, 3, v4
    ds_write_b64 v5, v[16:17] offset:2560
    s_waitcnt lgkmcnt(0)
    s_barrier
    s_cmp_lg_u32 s3, 0
    s_cbranch_scc1 P1_AUX5
    ds_read_b128 v[140:143], v1 offset:2560
    s_lshl_b32 s14, s20, 10
    s_add_u32 s14, s14, 10485760
    s_waitcnt lgkmcnt(0)
    buffer_store_dwordx4 v[140:143], v1, s[60:63], s14 offen sc1
    s_waitcnt vmcnt(0)
    s_lshl_b32 s14, s20, 8
    s_add_u32 s14, s14, 10977280
    v_mov_b32 v2, 1
    s_mov_b64 exec, 1
    buffer_store_dword v2, off, s[60:63], s14 offset:0 sc1
    s_mov_b64 exec, -1
P1_AUX5:
    ds_read_b128 v[100:103], v7 offset:0
    ds_read_b128 v[104:107], v7 offset:128
    ds_read_b128 v[108:111], v7 offset:256
    ds_read_b128 v[112:115], v7 offset:384
    ds_read_b128 v[116:119], v7 offset:512
    ds_read_b128 v[120:123], v7 offset:640
    ds_read_b128 v[124:127], v7 offset:768
    ds_read_b128 v[128:131], v7 offset:896
    ds_read_b128 v[132:135], v7 offset:1024
    ds_read_b128 v[136:139], v7 offset:1152
    s_waitcnt lgkmcnt(0)
    v_dot2c_f32_bf16 v14, s40, v100
    v_dot2c_f32_bf16 v14, s40, v101
    v_dot2c_f32_bf16 v14, s40, v102
    v_dot2c_f32_bf16 v14, s40, v103
    v_dot2c_f32_bf16 v14, s40, v104
    v_dot2c_f32_bf16 v14, s40, v105
    v_dot2c_f32_bf16 v14, s40, v106
    v_dot2c_f32_bf16 v14, s40, v107
    v_dot2c_f32_bf16 v14, s40, v108
    v_dot2c_f32_bf16 v14, s40, v109
    v_dot2c_f32_bf16 v14, s40, v110
    v_dot2c_f32_bf16 v14, s40, v111
    v_dot2c_f32_bf16 v14, s40, v112
    v_dot2c_f32_bf16 v14, s40, v113
    v_dot2c_f32_bf16 v14, s40, v114
    v_dot2c_f32_bf16 v14, s40, v115
    v_dot2c_f32_bf16 v14, s40, v116
    v_dot2c_f32_bf16 v14, s40, v117
    v_dot2c_f32_bf16 v14, s40, v118
    v_dot2c_f32_bf16 v14, s40, v119
    v_dot2c_f32_bf16 v14, s40, v120
    v_dot2c_f32_bf16 v14, s40, v121
    v_dot2c_f32_bf16 v14, s40, v122
    v_dot2c_f32_bf16 v14, s40, v123
    v_dot2c_f32_bf16 v14, s40, v124
    v_dot2c_f32_bf16 v14, s40, v125
    v_dot2c_f32_bf16 v14, s40, v126
    v_dot2c_f32_bf16 v14, s40, v127
    v_dot2c_f32_bf16 v14, s40, v128
    v_dot2c_f32_bf16 v14, s40, v129
    v_dot2c_f32_bf16 v14, s40, v130
    v_dot2c_f32_bf16 v14, s40, v131
    v_dot2c_f32_bf16 v14, s40, v132
    v_dot2c_f32_bf16 v14, s40, v133
    v_dot2c_f32_bf16 v14, s40, v134
    v_dot2c_f32_bf16 v14, s40, v135
    v_dot2c_f32_bf16 v14, s40, v136
    v_dot2c_f32_bf16 v14, s40, v137
    v_dot2c_f32_bf16 v14, s40, v138
    v_dot2c_f32_bf16 v14, s40, v139
    v_dot2c_f32_bf16 v10, v100, v20
    v_dot2c_f32_bf16 v13, v100, v60
    v_dot2c_f32_bf16 v10, v101, v21
    v_dot2c_f32_bf16 v13, v101, v61
    v_dot2c_f32_bf16 v10, v102, v22
    v_dot2c_f32_bf16 v13, v102, v62
    v_dot2c_f32_bf16 v10, v103, v23
    v_dot2c_f32_bf16 v13, v103, v63
    v_dot2c_f32_bf16 v10, v104, v24
    v_dot2c_f32_bf16 v13, v104, v64
    v_dot2c_f32_bf16 v10, v105, v25
    v_dot2c_f32_bf16 v13, v105, v65
    v_dot2c_f32_bf16 v10, v106, v26
    v_dot2c_f32_bf16 v13, v106, v66
    v_dot2c_f32_bf16 v10, v107, v27
    v_dot2c_f32_bf16 v13, v107, v67
    v_dot2c_f32_bf16 v10, v108, v28
    v_dot2c_f32_bf16 v13, v108, v68
    v_dot2c_f32_bf16 v10, v109, v29
    v_dot2c_f32_bf16 v13, v109, v69
    v_dot2c_f32_bf16 v10, v110, v30
    v_dot2c_f32_bf16 v13, v110, v70
    v_dot2c_f32_bf16 v10, v111, v31
    v_dot2c_f32_bf16 v13, v111, v71
    v_dot2c_f32_bf16 v10, v112, v32
    v_dot2c_f32_bf16 v13, v112, v72
    v_dot2c_f32_bf16 v10, v113, v33
    v_dot2c_f32_bf16 v13, v113, v73
    v_dot2c_f32_bf16 v10, v114, v34
    v_dot2c_f32_bf16 v13, v114, v74
    v_dot2c_f32_bf16 v10, v115, v35
    v_dot2c_f32_bf16 v13, v115, v75
    v_dot2c_f32_bf16 v10, v116, v36
    v_dot2c_f32_bf16 v13, v116, v76
    v_dot2c_f32_bf16 v10, v117, v37
    v_dot2c_f32_bf16 v13, v117, v77
    v_dot2c_f32_bf16 v10, v118, v38
    v_dot2c_f32_bf16 v13, v118, v78
    v_dot2c_f32_bf16 v10, v119, v39
    v_dot2c_f32_bf16 v13, v119, v79
    v_dot2c_f32_bf16 v10, v120, v40
    v_dot2c_f32_bf16 v13, v120, v80
    v_dot2c_f32_bf16 v10, v121, v41
    v_dot2c_f32_bf16 v13, v121, v81
    v_dot2c_f32_bf16 v10, v122, v42
    v_dot2c_f32_bf16 v13, v122, v82
    v_dot2c_f32_bf16 v10, v123, v43
    v_dot2c_f32_bf16 v13, v123, v83
    v_dot2c_f32_bf16 v10, v124, v44
    v_dot2c_f32_bf16 v13, v124, v84
    v_dot2c_f32_bf16 v10, v125, v45
    v_dot2c_f32_bf16 v13, v125, v85
    v_dot2c_f32_bf16 v10, v126, v46
    v_dot2c_f32_bf16 v13, v126, v86
    v_dot2c_f32_bf16 v10, v127, v47
    v_dot2c_f32_bf16 v13, v127, v87
    v_dot2c_f32_bf16 v10, v128, v48
    v_dot2c_f32_bf16 v13, v128, v88
    v_dot2c_f32_bf16 v10, v129, v49
    v_dot2c_f32_bf16 v13, v129, v89
    v_dot2c_f32_bf16 v10, v130, v50
    v_dot2c_f32_bf16 v13, v130, v90
    v_dot2c_f32_bf16 v10, v131, v51
    v_dot2c_f32_bf16 v13, v131, v91
    v_dot2c_f32_bf16 v10, v132, v52
    v_dot2c_f32_bf16 v13, v132, v92
    v_dot2c_f32_bf16 v10, v133, v53
    v_dot2c_f32_bf16 v13, v133, v93
    v_dot2c_f32_bf16 v10, v134, v54
    v_dot2c_f32_bf16 v13, v134, v94
    v_dot2c_f32_bf16 v10, v135, v55
    v_dot2c_f32_bf16 v13, v135, v95
    v_dot2c_f32_bf16 v10, v136, v56
    v_dot2c_f32_bf16 v13, v136, v96
    v_dot2c_f32_bf16 v10, v137, v57
    v_dot2c_f32_bf16 v13, v137, v97
    v_dot2c_f32_bf16 v10, v138, v58
    v_dot2c_f32_bf16 v13, v138, v98
    v_dot2c_f32_bf16 v10, v139, v59
    v_dot2c_f32_bf16 v13, v139, v99
    s_nop 1
    v_add_f32_dpp v10, v10, v10 quad_perm:[1,0,3,2] row_mask:0xf bank_mask:0xf
    v_add_f32_dpp v13, v13, v13 quad_perm:[1,0,3,2] row_mask:0xf bank_mask:0xf
    v_add_f32_dpp v14, v14, v14 quad_perm:[1,0,3,2] row_mask:0xf bank_mask:0xf
    v_add_f32_dpp v10, v10, v10 quad_perm:[2,3,0,1] row_mask:0xf bank_mask:0xf
    v_add_f32_dpp v13, v13, v13 quad_perm:[2,3,0,1] row_mask:0xf bank_mask:0xf
    v_add_f32_dpp v14, v14, v14 quad_perm:[2,3,0,1] row_mask:0xf bank_mask:0xf
    v_add_f32_dpp v10, v10, v10 row_half_mirror row_mask:0xf bank_mask:0xf
    v_add_f32_dpp v13, v13, v13 row_half_mirror row_mask:0xf bank_mask:0xf
    v_add_f32_dpp v14, v14, v14 row_half_mirror row_mask:0xf bank_mask:0xf
    v_and_b32 v2, 1, v0
    v_cmp_eq_u32 vcc, 1, v2
    s_lshl_b32 s14, s20, 7
    v_add_u32 v5, s14, v4
    v_cndmask_b32 v10, v10, v13, vcc
    v_fma_f32 v2, -v16, v14, v10
    v_mul_f32 v2, v2, v17
    v_cvt_pk_bf16_f32 v2, v2, v2
    v_ashrrev_i32 v3, 31, v2
    v_or_b32 v3, 0x80000000, v3
    v_xor_b32 v2, v2, v3
    v_and_b32 v2, 0xffff0000, v2
    v_sub_u32 v3, 0xffff, v5
    v_or_b32 v2, v2, v3
    v_lshlrev_b32 v3, 2, v4
    ds_write_b32 v3, v2 offset:2048
    s_waitcnt vmcnt(0) lgkmcnt(0)
    s_barrier
    s_cmp_lg_u32 s3, 7
    s_cbranch_scc1 P1_AUX3
    v_lshlrev_b32 v2, 3, v0
    ds_read_b64 v[16:17], v2 offset:2048
    s_waitcnt lgkmcnt(0)
    v_max_u32 v3, v16, v17
    s_nop 1
    v_max_u32_dpp v2, v3, v3 quad_perm:[1,0,3,2] row_mask:0xf bank_mask:0xf
    s_nop 1
    v_max_u32_dpp v2, v2, v2 quad_perm:[2,3,0,1] row_mask:0xf bank_mask:0xf
    s_nop 1
    v_max_u32_dpp v2, v2, v2 row_half_mirror row_mask:0xf bank_mask:0xf
    s_nop 1
    v_max_u32_dpp v2, v2, v2 row_mirror row_mask:0xf bank_mask:0xf
    s_nop 0
    v_readlane_b32 s44, v2, 0
    v_readlane_b32 s45, v2, 16
    v_readlane_b32 s46, v2, 32
    v_readlane_b32 s47, v2, 48
    s_max_u32 s44, s44, s45
    s_max_u32 s46, s46, s47
    s_max_u32 s48, s44, s46
    v_cmp_ne_u32 vcc, s48, v16
    s_nop 1
    v_cndmask_b32 v16, 0, v16, vcc
    v_cmp_ne_u32 vcc, s48, v17
    s_nop 1
    v_cndmask_b32 v17, 0, v17, vcc
    v_max_u32 v3, v16, v17
    s_nop 1
    v_max_u32_dpp v2, v3, v3 quad_perm:[1,0,3,2] row_mask:0xf bank_mask:0xf
    s_nop 1
    v_max_u32_dpp v2, v2, v2 quad_perm:[2,3,0,1] row_mask:0xf bank_mask:0xf
    s_nop 1
    v_max_u32_dpp v2, v2, v2 row_half_mirror row_mask:0xf bank_mask:0xf
    s_nop 1
    v_max_u32_dpp v2, v2, v2 row_mirror row_mask:0xf bank_mask:0xf
    s_nop 0
    v_readlane_b32 s44, v2, 0
    v_readlane_b32 s45, v2, 16
    v_readlane_b32 s46, v2, 32
    v_readlane_b32 s47, v2, 48
    s_max_u32 s44, s44, s45
    s_max_u32 s46, s46, s47
    s_max_u32 s49, s44, s46
    v_mov_b32 v16, s48
    v_mov_b32 v17, s49
    s_lshl_b32 s14, s20, 3
    s_add_u32 s14, s14, 10502144
    s_mov_b64 exec, 1
    buffer_store_dwordx2 v[16:17], off, s[60:63], s14 sc1
    s_mov_b64 exec, -1
P1_AUX3:
    s_cmp_lg_u32 s3, 4
    s_cbranch_scc1 P1_AUX6
    v_mov_b32 v2, 192
    s_and_b32 s14, s2, 7
    s_lshl_b32 s14, s14, 1
    s_bfe_u32 s15, s2, 0x10004
    s_add_u32 s14, s14, s15
    s_sub_u32 s14, s14, s20
    v_and_b32 v4, 1, v0
    v_mul_i32_i24 v4, s14, v4
    v_add_u32 v4, s20, v4
    v_lshlrev_b32 v4, 8, v4
    v_add_u32 v4, 10977280, v4
    s_mov_b32 s14, 0
POLL3:
    buffer_load_dword v3, v2, s[32:35], 0 offen sc1
    s_add_u32 s14, s14, 1
    s_cmp_gt_u32 s14, 200000
    s_cbranch_scc1 POLLX3
    s_waitcnt vmcnt(0)
    v_cmp_eq_u32 vcc, 0, v3
    s_nop 0
    s_mov_b64 exec, vcc
    s_cbranch_execnz POLL3
POLLX3:
    s_mov_b64 exec, -1
    s_waitcnt vmcnt(0)
    s_mov_b32 s14, 0
POLL4:
    buffer_load_dword v3, v4, s[60:63], 0 offen sc1
    s_add_u32 s14, s14, 1
    s_cmp_gt_u32 s14, 200000
    s_cbranch_scc1 POLLX4
    s_waitcnt vmcnt(0)
    v_cmp_eq_u32 vcc, 0, v3
    s_nop 0
    s_mov_b64 exec, vcc
    s_cbranch_execnz POLL4
POLLX4:
    s_mov_b64 exec, -1
    s_waitcnt vmcnt(0)
P1_AUX6:
    s_waitcnt vmcnt(0)
    s_barrier
    s_cmp_lg_u32 s3, 7
    s_cbranch_scc1 P1_AUX7
    s_lshl_b32 s14, s20, 8
    s_add_u32 s14, s14, 10960896
    v_mov_b32 v2, 1
    s_mov_b64 exec, 1
    buffer_store_dword v2, off, s[60:63], s14 offset:0 sc1
    s_mov_b64 exec, -1
P1_AUX7:
    s_mov_b32 s57, -1
    s_cmp_lt_u32 s3, 4
    s_cbranch_scc1 P2_COMP
    s_branch P2_PREP
P2_COMP:
    s_and_b32 s16, s2, 7
    s_lshl_b32 s17, s16, 2
    s_lshr_b32 s18, s2, 3
    s_and_b32 s19, s18, 3
    s_add_u32 s20, s17, s19
    s_lshr_b32 s21, s2, 5
    s_lshr_b32 s17, s20, 1
    s_lshl_b32 s17, s17, 15
    s_and_b32 s19, s20, 1
    s_lshl_b32 s19, s19, 3
    s_add_u32 s51, s17, s19
    s_add_u32 s48, s51, 7340032
    s_mov_b32 s28, s20
    s_mov_b32 s29, s21
    s_and_b32 s22, s3, 1
    s_lshr_b32 s23, s3, 1
    s_lshl_b32 s18, s21, 1
    s_add_u32 s18, s18, s22
    s_lshl_b32 s19, s18, 12
    s_lshl_b32 s17, s20, 16
    s_add_u32 s49, s17, s19
    s_lshl_b32 s19, s18, 11
    s_add_u32 s50, s51, s19
    s_add_u32 s50, s50, 2097152
    s_xor_b32 s16, s23, 1
    s_lshl_b32 s17, s16, 11
    s_add_u32 s54, s49, s17
    s_lshl_b32 s17, s16, 10
    s_add_u32 s55, s50, s17
    s_lshl_b32 s17, s23, 11
    s_add_u32 s49, s49, s17
    s_lshl_b32 s17, s23, 10
    s_add_u32 s50, s50, s17
    s_mov_b32 s26, 0
    s_mov_b32 s53, 0x07060302
    s_mov_b32 s30, 0x000fffff
    s_mov_b32 s31, 0x000fffff
    s_mul_i32 s16, s23, 81920
    v_and_b32 v2, 31, v0
    v_lshrrev_b32 v4, 5, v0
    v_add_u32 v6, s16, v1
    s_add_u32 s17, s16, 73728
    v_lshl_add_u32 v7, v2, 3, s17
    v_lshl_add_u32 v7, v4, 2, v7
    v_mul_u32_u24 v8, 320, v4
    v_lshl_add_u32 v8, v2, 4, v8
    s_add_u32 s17, s16, 1024
    v_add_u32 v8, s17, v8
    v_lshlrev_b32 v5, 4, v2
    v_lshl_add_u32 v11, v4, 2, v5
    v_mov_b32 v29, 0
    v_mov_b32 v31, 0
    v_mov_b32 v33, 0
    v_mov_b32 v35, 0
    v_mov_b32 v221, 0
    v_mov_b32 v223, 0
    s_mul_i32 s17, s20, 147456
    s_add_u32 s17, s17, 2621440
    s_add_u32 s32, s84, s17
    s_addc_u32 s33, s85, 0
    s_mov_b32 s34, 147456
    s_mov_b32 s35, 0x00020000
    s_lshl_b32 s16, s21, 2
    s_xor_b32 s17, s23, 1
    s_add_u32 s16, s16, s17
    s_lshl_b32 s17, s22, 1
    s_add_u32 s52, s16, s17
    s_lshl_b32 s16, s52, 16
    s_lshl_b32 s17, s20, 9
    s_add_u32 s16, s16, s17
    s_add_u32 s16, s16, 7864320
    v_bfe_u32 v2, v0, 4, 1
    v_and_b32 v3, 15, v0
    v_lshrrev_b32 v4, 5, v0
    v_lshlrev_b32 v9, 14, v2
    v_lshl_add_u32 v9, v3, 4, v9
    v_lshl_add_u32 v9, v4, 8, v9
    v_add_u32 v9, s16, v9
    s_lshl_b32 s16, s52, 14
    s_lshl_b32 s17, s20, 7
    s_add_u32 s16, s16, s17
    s_add_u32 s16, s16, 9961472
    v_lshlrev_b32 v10, 12, v2
    v_lshl_add_u32 v10, v3, 3, v10
    v_lshl_add_u32 v10, v4, 30, v10
    v_add_u32 v10, s16, v10
    v_and_b32 v2, 27, v0
    v_cmp_eq_u32 vcc, 24, v2
    v_mov_b32 v3, 1065369472
    s_nop 0
    v_cndmask_b32 v224, 0, v3, vcc
    v_cndmask_b32 v225, 0, v3, vcc
    v_pk_mov_b32 v[226:227], v[224:225], v[224:225]
    v_pk_mov_b32 v[228:229], v[224:225], v[224:225]
    v_pk_mov_b32 v[230:231], v[224:225], v[224:225]
    v_pk_mov_b32 v[232:233], v[224:225], v[224:225]
    v_pk_mov_b32 v[234:235], v[224:225], v[224:225]
    v_pk_mov_b32 v[236:237], v[224:225], v[224:225]
    v_pk_mov_b32 v[238:239], v[224:225], v[224:225]
    v_mov_b32 v132, 0
    v_mov_b32 v133, 0
    v_pk_mov_b32 v[134:135], v[132:133], v[132:133]
    v_pk_mov_b32 v[136:137], v[132:133], v[132:133]
    v_pk_mov_b32 v[138:139], v[132:133], v[132:133]
    v_pk_mov_b32 v[140:141], v[132:133], v[132:133]
    v_pk_mov_b32 v[142:143], v[132:133], v[132:133]
    v_pk_mov_b32 v[144:145], v[132:133], v[132:133]
    v_pk_mov_b32 v[146:147], v[132:133], v[132:133]
    v_pk_mov_b32 v[148:149], v[132:133], v[132:133]
    v_pk_mov_b32 v[150:151], v[132:133], v[132:133]
    v_pk_mov_b32 v[152:153], v[132:133], v[132:133]
    v_pk_mov_b32 v[154:155], v[132:133], v[132:133]
    v_pk_mov_b32 v[156:157], v[132:133], v[132:133]
    v_pk_mov_b32 v[158:159], v[132:133], v[132:133]
    v_pk_mov_b32 v[160:161], v[132:133], v[132:133]
    v_pk_mov_b32 v[162:163], v[132:133], v[132:133]
    v_pk_mov_b32 v[164:165], v[132:133], v[132:133]
    v_pk_mov_b32 v[166:167], v[132:133], v[132:133]
    v_pk_mov_b32 v[168:169], v[132:133], v[132:133]
    v_pk_mov_b32 v[170:171], v[132:133], v[132:133]
    v_pk_mov_b32 v[172:173], v[132:133], v[132:133]
    v_pk_mov_b32 v[174:175], v[132:133], v[132:133]
    v_pk_mov_b32 v[176:177], v[132:133], v[132:133]
    v_pk_mov_b32 v[178:179], v[132:133], v[132:133]
    v_pk_mov_b32 v[180:181], v[132:133], v[132:133]
    v_pk_mov_b32 v[182:183], v[132:133], v[132:133]
    v_pk_mov_b32 v[184:185], v[132:133], v[132:133]
    v_pk_mov_b32 v[186:187], v[132:133], v[132:133]
    v_pk_mov_b32 v[188:189], v[132:133], v[132:133]
    v_pk_mov_b32 v[190:191], v[132:133], v[132:133]
    v_pk_mov_b32 v[192:193], v[132:133], v[132:133]
    v_pk_mov_b32 v[194:195], v[132:133], v[132:133]
    v_pk_mov_b32 v[204:205], v[132:133], v[132:133]
    v_pk_mov_b32 v[206:207], v[132:133], v[132:133]
    v_pk_mov_b32 v[208:209], v[132:133], v[132:133]
    v_pk_mov_b32 v[210:211], v[132:133], v[132:133]
    s_barrier
    buffer_load_dwordx4 v[212:215], v1, s[32:35], 0 offen sc1
    buffer_load_dword v220, v11, s[60:63], s48 offen sc1
    buffer_load_dwordx2 v[196:197], v1, s[60:63], s50 offen sc1
    buffer_load_dwordx4 v[12:15], v1, s[60:63], s49 offen offset:0 sc1
    buffer_load_dwordx4 v[16:19], v1, s[60:63], s49 offen offset:1024 sc1
    buffer_load_dwordx2 v[198:199], v1, s[60:63], s55 offen sc1
    buffer_load_dwordx4 v[20:23], v1, s[60:63], s54 offen offset:0 sc1
    buffer_load_dwordx4 v[24:27], v1, s[60:63], s54 offen offset:1024 sc1
    s_waitcnt vmcnt(4)
    v_permlane32_swap_b32 v196, v197
    v_mov_b32 v28, v196
    v_mov_b32 v30, v197
    v_mfma_f32_32x32x16_bf16 v[36:51], v[212:215], v[12:15], 0
    v_mfma_f32_32x32x8bf16_1k v[36:51], v[220:221], v[28:29], v[36:51]
    s_waitcnt vmcnt(3)
    v_mfma_f32_32x32x16_bf16 v[52:67], v[212:215], v[16:19], 0
    v_mfma_f32_32x32x8bf16_1k v[52:67], v[220:221], v[30:31], v[52:67]
    s_waitcnt vmcnt(1)
    v_permlane32_swap_b32 v198, v199
    v_mov_b32 v32, v198
    v_mov_b32 v34, v199
    v_mfma_f32_32x32x16_bf16 v[68:83], v[212:215], v[20:23], 0
    v_mfma_f32_32x32x8bf16_1k v[68:83], v[220:221], v[32:33], v[68:83]
    s_waitcnt vmcnt(0)
    v_mfma_f32_32x32x16_bf16 v[84:99], v[212:215], v[24:27], 0
    v_mfma_f32_32x32x8bf16_1k v[84:99], v[220:221], v[34:35], v[84:99]
    v_max3_f32 v240, v36, v37, v38
    v_max3_f32 v240, v240, v39, v40
    v_max3_f32 v240, v240, v41, v42
    v_max3_f32 v240, v240, v43, v44
    v_max3_f32 v240, v240, v45, v46
    v_max3_f32 v240, v240, v47, v48
    v_max3_f32 v240, v240, v49, v50
    v_max_f32 v240, v240, v51
    v_max3_f32 v241, v52, v53, v54
    v_max3_f32 v241, v241, v55, v56
    v_max3_f32 v241, v241, v57, v58
    v_max3_f32 v241, v241, v59, v60
    v_max3_f32 v241, v241, v61, v62
    v_max3_f32 v241, v241, v63, v64
    v_max3_f32 v241, v241, v65, v66
    v_max_f32 v241, v241, v67
    v_max3_f32 v242, v68, v69, v70
    v_max3_f32 v242, v242, v71, v72
    v_max3_f32 v242, v242, v73, v74
    v_max3_f32 v242, v242, v75, v76
    v_max3_f32 v242, v242, v77, v78
    v_max3_f32 v242, v242, v79, v80
    v_max3_f32 v242, v242, v81, v82
    v_max_f32 v242, v242, v83
    v_max3_f32 v243, v84, v85, v86
    v_max3_f32 v243, v243, v87, v88
    v_max3_f32 v243, v243, v89, v90
    v_max3_f32 v243, v243, v91, v92
    v_max3_f32 v243, v243, v93, v94
    v_max3_f32 v243, v243, v95, v96
    v_max3_f32 v243, v243, v97, v98
    v_max_f32 v243, v243, v99
    v_mov_b32 v2, v240
    v_mov_b32 v3, v241
    v_mov_b32 v4, v242
    v_mov_b32 v5, v243
    v_permlane32_swap_b32 v240, v2
    v_permlane32_swap_b32 v241, v3
    v_permlane32_swap_b32 v242, v4
    v_permlane32_swap_b32 v243, v5
    v_max_f32 v240, v240, v2
    v_max_f32 v241, v241, v3
    v_max_f32 v242, v242, v4
    v_max_f32 v243, v243, v5
    v_xor_b32 v36, 0x80000000, v240
    v_xor_b32 v52, 0x80000000, v241
    v_xor_b32 v68, 0x80000000, v242
    v_xor_b32 v84, 0x80000000, v243
    v_xor_b32 v37, 0x80000000, v240
    v_xor_b32 v53, 0x80000000, v241
    v_xor_b32 v69, 0x80000000, v242
    v_xor_b32 v85, 0x80000000, v243
    v_pk_mov_b32 v[38:39], v[36:37], v[36:37]
    v_pk_mov_b32 v[54:55], v[52:53], v[52:53]
    v_pk_mov_b32 v[70:71], v[68:69], v[68:69]
    v_pk_mov_b32 v[86:87], v[84:85], v[84:85]
    v_pk_mov_b32 v[40:41], v[36:37], v[36:37]
    v_pk_mov_b32 v[56:57], v[52:53], v[52:53]
    v_pk_mov_b32 v[72:73], v[68:69], v[68:69]
    v_pk_mov_b32 v[88:89], v[84:85], v[84:85]
    v_pk_mov_b32 v[42:43], v[36:37], v[36:37]
    v_pk_mov_b32 v[58:59], v[52:53], v[52:53]
    v_pk_mov_b32 v[74:75], v[68:69], v[68:69]
    v_pk_mov_b32 v[90:91], v[84:85], v[84:85]
    v_pk_mov_b32 v[44:45], v[36:37], v[36:37]
    v_pk_mov_b32 v[60:61], v[52:53], v[52:53]
    v_pk_mov_b32 v[76:77], v[68:69], v[68:69]
    v_pk_mov_b32 v[92:93], v[84:85], v[84:85]
    v_pk_mov_b32 v[46:47], v[36:37], v[36:37]
    v_pk_mov_b32 v[62:63], v[52:53], v[52:53]
    v_pk_mov_b32 v[78:79], v[68:69], v[68:69]
    v_pk_mov_b32 v[94:95], v[84:85], v[84:85]
    v_pk_mov_b32 v[48:49], v[36:37], v[36:37]
    v_pk_mov_b32 v[64:65], v[52:53], v[52:53]
    v_pk_mov_b32 v[80:81], v[68:69], v[68:69]
    v_pk_mov_b32 v[96:97], v[84:85], v[84:85]
    v_pk_mov_b32 v[50:51], v[36:37], v[36:37]
    v_pk_mov_b32 v[66:67], v[52:53], v[52:53]
    v_pk_mov_b32 v[82:83], v[68:69], v[68:69]
    v_pk_mov_b32 v[98:99], v[84:85], v[84:85]
P2_MAIN:
    s_setprio 1
    s_lshl_b32 s16, s22, 13
    s_add_u32 s16, s16, 53760
    s_mul_i32 s17, s23, 81920
    s_add_u32 s17, s17, s16
    v_add_u32 v11, s17, v1
    s_xor_b32 s17, s23, 1
    s_mul_i32 s17, s17, 81920
    s_add_u32 s17, s17, s16
    v_add_u32 v3, s17, v1
    s_barrier
    ds_read_b128 v[212:215], v6 offset:0
    ds_read_b32 v220, v7 offset:0
    s_mov_b64 exec, s[30:31]
    ds_read_b128 v[224:227], v8 offset:0
    ds_read_b128 v[228:231], v8 offset:640
    s_mov_b64 exec, -1
    s_mov_b32 s24, 0
    s_mov_b32 s25, 1
    s_waitcnt lgkmcnt(2)
    v_mfma_f32_32x32x16_bf16 v[100:115], v[212:215], v[12:15], v[36:51]
    v_mfma_f32_32x32x8bf16_1k v[100:115], v[220:221], v[28:29], v[100:115]
    s_nop 8
.p2align 6
P2_LOOP:
    v_mfma_f32_32x32x16_bf16 v[116:131], v[212:215], v[16:19], v[52:67]
    ds_read_b128 v[216:219], v6 offset:2304
    ds_read_b32 v222, v7 offset:256
    v_exp_f32 v100, v100
    v_exp_f32 v101, v101
    v_exp_f32 v102, v102
    v_exp_f32 v103, v103
    v_mfma_f32_32x32x8bf16_1k v[116:131], v[220:221], v[30:31], v[116:131]
    v_cvt_pk_bf16_f32 v196, v100, v101
    v_cvt_pk_bf16_f32 v197, v102, v103
    v_exp_f32 v104, v104
    v_exp_f32 v105, v105
    v_exp_f32 v106, v106
    v_exp_f32 v107, v107
    v_mfma_f32_32x32x16_bf16 v[180:195], v[232:235], v[204:207], v[180:195]
    v_cvt_pk_bf16_f32 v198, v104, v105
    v_cvt_pk_bf16_f32 v199, v106, v107
    v_exp_f32 v108, v108
    v_exp_f32 v109, v109
    v_exp_f32 v110, v110
    v_exp_f32 v111, v111
    v_mfma_f32_32x32x16_bf16 v[180:195], v[236:239], v[208:211], v[180:195]
    s_waitcnt lgkmcnt(2)
    v_cvt_pk_bf16_f32 v200, v108, v109
    v_cvt_pk_bf16_f32 v201, v110, v111
    v_exp_f32 v112, v112
    v_exp_f32 v113, v113
    v_exp_f32 v114, v114
    v_exp_f32 v115, v115
    v_cvt_pk_bf16_f32 v202, v112, v113
    v_cvt_pk_bf16_f32 v203, v114, v115
    v_mfma_f32_32x32x16_bf16 v[100:115], v[212:215], v[20:23], v[68:83]
    s_mov_b64 exec, s[30:31]
    ds_read_b128 v[232:235], v8 offset:2304
    ds_read_b128 v[236:239], v8 offset:2944
    s_mov_b64 exec, -1
    v_exp_f32 v116, v116
    v_exp_f32 v117, v117
    v_exp_f32 v118, v118
    v_exp_f32 v119, v119
    v_mfma_f32_32x32x8bf16_1k v[100:115], v[220:221], v[32:33], v[100:115]
    v_cvt_pk_bf16_f32 v204, v116, v117
    v_cvt_pk_bf16_f32 v205, v118, v119
    v_exp_f32 v120, v120
    v_exp_f32 v121, v121
    v_exp_f32 v122, v122
    v_exp_f32 v123, v123
    v_mfma_f32_32x32x16_bf16 v[132:147], v[224:227], v[196:199], v[132:147]
    v_cvt_pk_bf16_f32 v206, v120, v121
    v_cvt_pk_bf16_f32 v207, v122, v123
    v_exp_f32 v124, v124
    v_exp_f32 v125, v125
    v_exp_f32 v126, v126
    v_exp_f32 v127, v127
    v_mfma_f32_32x32x16_bf16 v[132:147], v[228:231], v[200:203], v[132:147]
    v_cvt_pk_bf16_f32 v208, v124, v125
    v_cvt_pk_bf16_f32 v209, v126, v127
    v_exp_f32 v128, v128
    v_exp_f32 v129, v129
    v_exp_f32 v130, v130
    v_exp_f32 v131, v131
    v_cvt_pk_bf16_f32 v210, v128, v129
    v_cvt_pk_bf16_f32 v211, v130, v131
    v_mfma_f32_32x32x16_bf16 v[116:131], v[212:215], v[24:27], v[84:99]
    v_exp_f32 v100, v100
    v_exp_f32 v101, v101
    v_exp_f32 v102, v102
    v_exp_f32 v103, v103
    v_mfma_f32_32x32x8bf16_1k v[116:131], v[220:221], v[34:35], v[116:131]
    v_cvt_pk_bf16_f32 v196, v100, v101
    v_cvt_pk_bf16_f32 v197, v102, v103
    v_exp_f32 v104, v104
    v_exp_f32 v105, v105
    v_exp_f32 v106, v106
    v_exp_f32 v107, v107
    v_mfma_f32_32x32x16_bf16 v[148:163], v[224:227], v[204:207], v[148:163]
    v_cvt_pk_bf16_f32 v198, v104, v105
    v_cvt_pk_bf16_f32 v199, v106, v107
    v_exp_f32 v108, v108
    v_exp_f32 v109, v109
    v_exp_f32 v110, v110
    v_exp_f32 v111, v111
    v_mfma_f32_32x32x16_bf16 v[148:163], v[228:231], v[208:211], v[148:163]
    s_waitcnt lgkmcnt(2)
    v_cvt_pk_bf16_f32 v200, v108, v109
    v_cvt_pk_bf16_f32 v201, v110, v111
    v_exp_f32 v112, v112
    v_exp_f32 v113, v113
    v_exp_f32 v114, v114
    v_exp_f32 v115, v115
    v_cvt_pk_bf16_f32 v202, v112, v113
    v_cvt_pk_bf16_f32 v203, v114, v115
    v_mfma_f32_32x32x16_bf16 v[100:115], v[216:219], v[12:15], v[36:51]
    v_exp_f32 v116, v116
    v_exp_f32 v117, v117
    v_exp_f32 v118, v118
    v_exp_f32 v119, v119
    v_mfma_f32_32x32x8bf16_1k v[100:115], v[222:223], v[28:29], v[100:115]
    v_cvt_pk_bf16_f32 v204, v116, v117
    v_cvt_pk_bf16_f32 v205, v118, v119
    v_exp_f32 v120, v120
    v_exp_f32 v121, v121
    v_exp_f32 v122, v122
    v_exp_f32 v123, v123
    v_mfma_f32_32x32x16_bf16 v[164:179], v[224:227], v[196:199], v[164:179]
    v_cvt_pk_bf16_f32 v206, v120, v121
    v_cvt_pk_bf16_f32 v207, v122, v123
    v_exp_f32 v124, v124
    v_exp_f32 v125, v125
    v_exp_f32 v126, v126
    v_exp_f32 v127, v127
    v_mfma_f32_32x32x16_bf16 v[164:179], v[228:231], v[200:203], v[164:179]
    v_cvt_pk_bf16_f32 v208, v124, v125
    v_cvt_pk_bf16_f32 v209, v126, v127
    v_exp_f32 v128, v128
    v_exp_f32 v129, v129
    v_exp_f32 v130, v130
    v_exp_f32 v131, v131
    v_cvt_pk_bf16_f32 v210, v128, v129
    v_cvt_pk_bf16_f32 v211, v130, v131
    v_mfma_f32_32x32x16_bf16 v[116:131], v[216:219], v[16:19], v[52:67]
    ds_read_b128 v[212:215], v6 offset:4608
    ds_read_b32 v220, v7 offset:512
    v_exp_f32 v100, v100
    v_exp_f32 v101, v101
    v_exp_f32 v102, v102
    v_exp_f32 v103, v103
    v_mfma_f32_32x32x8bf16_1k v[116:131], v[222:223], v[30:31], v[116:131]
    v_cvt_pk_bf16_f32 v196, v100, v101
    v_cvt_pk_bf16_f32 v197, v102, v103
    v_exp_f32 v104, v104
    v_exp_f32 v105, v105
    v_exp_f32 v106, v106
    v_exp_f32 v107, v107
    v_mfma_f32_32x32x16_bf16 v[180:195], v[224:227], v[204:207], v[180:195]
    v_cvt_pk_bf16_f32 v198, v104, v105
    v_cvt_pk_bf16_f32 v199, v106, v107
    v_exp_f32 v108, v108
    v_exp_f32 v109, v109
    v_exp_f32 v110, v110
    v_exp_f32 v111, v111
    v_mfma_f32_32x32x16_bf16 v[180:195], v[228:231], v[208:211], v[180:195]
    s_waitcnt lgkmcnt(2)
    v_cvt_pk_bf16_f32 v200, v108, v109
    v_cvt_pk_bf16_f32 v201, v110, v111
    v_exp_f32 v112, v112
    v_exp_f32 v113, v113
    v_exp_f32 v114, v114
    v_exp_f32 v115, v115
    v_cvt_pk_bf16_f32 v202, v112, v113
    v_cvt_pk_bf16_f32 v203, v114, v115
    v_mfma_f32_32x32x16_bf16 v[100:115], v[216:219], v[20:23], v[68:83]
    s_mov_b64 exec, s[30:31]
    ds_read_b128 v[224:227], v8 offset:4608
    ds_read_b128 v[228:231], v8 offset:5248
    s_mov_b64 exec, -1
    v_exp_f32 v116, v116
    v_exp_f32 v117, v117
    v_exp_f32 v118, v118
    v_exp_f32 v119, v119
    v_mfma_f32_32x32x8bf16_1k v[100:115], v[222:223], v[32:33], v[100:115]
    v_cvt_pk_bf16_f32 v204, v116, v117
    v_cvt_pk_bf16_f32 v205, v118, v119
    v_exp_f32 v120, v120
    v_exp_f32 v121, v121
    v_exp_f32 v122, v122
    v_exp_f32 v123, v123
    v_mfma_f32_32x32x16_bf16 v[132:147], v[232:235], v[196:199], v[132:147]
    v_cvt_pk_bf16_f32 v206, v120, v121
    v_cvt_pk_bf16_f32 v207, v122, v123
    v_exp_f32 v124, v124
    v_exp_f32 v125, v125
    v_exp_f32 v126, v126
    v_exp_f32 v127, v127
    v_mfma_f32_32x32x16_bf16 v[132:147], v[236:239], v[200:203], v[132:147]
    v_cvt_pk_bf16_f32 v208, v124, v125
    v_cvt_pk_bf16_f32 v209, v126, v127
    v_exp_f32 v128, v128
    v_exp_f32 v129, v129
    v_exp_f32 v130, v130
    v_exp_f32 v131, v131
    v_cvt_pk_bf16_f32 v210, v128, v129
    v_cvt_pk_bf16_f32 v211, v130, v131
    v_mfma_f32_32x32x16_bf16 v[116:131], v[216:219], v[24:27], v[84:99]
    v_exp_f32 v100, v100
    v_exp_f32 v101, v101
    v_exp_f32 v102, v102
    v_exp_f32 v103, v103
    v_mfma_f32_32x32x8bf16_1k v[116:131], v[222:223], v[34:35], v[116:131]
    v_cvt_pk_bf16_f32 v196, v100, v101
    v_cvt_pk_bf16_f32 v197, v102, v103
    v_exp_f32 v104, v104
    v_exp_f32 v105, v105
    v_exp_f32 v106, v106
    v_exp_f32 v107, v107
    v_mfma_f32_32x32x16_bf16 v[148:163], v[232:235], v[204:207], v[148:163]
    v_cvt_pk_bf16_f32 v198, v104, v105
    v_cvt_pk_bf16_f32 v199, v106, v107
    v_exp_f32 v108, v108
    v_exp_f32 v109, v109
    v_exp_f32 v110, v110
    v_exp_f32 v111, v111
    v_mfma_f32_32x32x16_bf16 v[148:163], v[236:239], v[208:211], v[148:163]
    s_waitcnt lgkmcnt(2)
    v_cvt_pk_bf16_f32 v200, v108, v109
    v_cvt_pk_bf16_f32 v201, v110, v111
    v_exp_f32 v112, v112
    v_exp_f32 v113, v113
    v_exp_f32 v114, v114
    v_exp_f32 v115, v115
    v_cvt_pk_bf16_f32 v202, v112, v113
    v_cvt_pk_bf16_f32 v203, v114, v115
    v_mfma_f32_32x32x16_bf16 v[100:115], v[212:215], v[12:15], v[36:51]
    s_add_u32 s24, s24, 1
    v_exp_f32 v116, v116
    v_exp_f32 v117, v117
    v_exp_f32 v118, v118
    v_exp_f32 v119, v119
    v_mfma_f32_32x32x8bf16_1k v[100:115], v[220:221], v[28:29], v[100:115]
    v_cvt_pk_bf16_f32 v204, v116, v117
    v_cvt_pk_bf16_f32 v205, v118, v119
    v_exp_f32 v120, v120
    v_exp_f32 v121, v121
    v_exp_f32 v122, v122
    v_exp_f32 v123, v123
    v_mfma_f32_32x32x16_bf16 v[164:179], v[232:235], v[196:199], v[164:179]
    s_cmp_lg_u32 s24, s25
    v_cvt_pk_bf16_f32 v206, v120, v121
    v_cvt_pk_bf16_f32 v207, v122, v123
    v_exp_f32 v124, v124
    v_exp_f32 v125, v125
    v_exp_f32 v126, v126
    v_exp_f32 v127, v127
    v_mfma_f32_32x32x16_bf16 v[164:179], v[236:239], v[200:203], v[164:179]
    v_cvt_pk_bf16_f32 v208, v124, v125
    v_cvt_pk_bf16_f32 v209, v126, v127
    v_exp_f32 v128, v128
    v_exp_f32 v129, v129
    v_exp_f32 v130, v130
    v_exp_f32 v131, v131
    v_cvt_pk_bf16_f32 v210, v128, v129
    v_cvt_pk_bf16_f32 v211, v130, v131
    s_cbranch_scc0 P2_EV1
P2_BK1:
    v_mfma_f32_32x32x16_bf16 v[116:131], v[212:215], v[16:19], v[52:67]
    ds_read_b128 v[216:219], v6 offset:6912
    ds_read_b32 v222, v7 offset:768
    v_exp_f32 v100, v100
    v_exp_f32 v101, v101
    v_exp_f32 v102, v102
    v_exp_f32 v103, v103
    v_mfma_f32_32x32x8bf16_1k v[116:131], v[220:221], v[30:31], v[116:131]
    v_cvt_pk_bf16_f32 v196, v100, v101
    v_cvt_pk_bf16_f32 v197, v102, v103
    v_exp_f32 v104, v104
    v_exp_f32 v105, v105
    v_exp_f32 v106, v106
    v_exp_f32 v107, v107
    v_mfma_f32_32x32x16_bf16 v[180:195], v[232:235], v[204:207], v[180:195]
    v_cvt_pk_bf16_f32 v198, v104, v105
    v_cvt_pk_bf16_f32 v199, v106, v107
    v_exp_f32 v108, v108
    v_exp_f32 v109, v109
    v_exp_f32 v110, v110
    v_exp_f32 v111, v111
    v_mfma_f32_32x32x16_bf16 v[180:195], v[236:239], v[208:211], v[180:195]
    s_waitcnt lgkmcnt(2)
    v_cvt_pk_bf16_f32 v200, v108, v109
    v_cvt_pk_bf16_f32 v201, v110, v111
    v_exp_f32 v112, v112
    v_exp_f32 v113, v113
    v_exp_f32 v114, v114
    v_exp_f32 v115, v115
    v_cvt_pk_bf16_f32 v202, v112, v113
    v_cvt_pk_bf16_f32 v203, v114, v115
    v_mfma_f32_32x32x16_bf16 v[100:115], v[212:215], v[20:23], v[68:83]
    s_mov_b64 exec, s[30:31]
    ds_read_b128 v[232:235], v8 offset:6912
    ds_read_b128 v[236:239], v8 offset:7552
    s_mov_b64 exec, -1
    v_exp_f32 v116, v116
    v_exp_f32 v117, v117
    v_exp_f32 v118, v118
    v_exp_f32 v119, v119
    v_mfma_f32_32x32x8bf16_1k v[100:115], v[220:221], v[32:33], v[100:115]
    v_cvt_pk_bf16_f32 v204, v116, v117
    v_cvt_pk_bf16_f32 v205, v118, v119
    v_exp_f32 v120, v120
    v_exp_f32 v121, v121
    v_exp_f32 v122, v122
    v_exp_f32 v123, v123
    v_mfma_f32_32x32x16_bf16 v[132:147], v[224:227], v[196:199], v[132:147]
    v_cvt_pk_bf16_f32 v206, v120, v121
    v_cvt_pk_bf16_f32 v207, v122, v123
    v_exp_f32 v124, v124
    v_exp_f32 v125, v125
    v_exp_f32 v126, v126
    v_exp_f32 v127, v127
    v_mfma_f32_32x32x16_bf16 v[132:147], v[228:231], v[200:203], v[132:147]
    v_cvt_pk_bf16_f32 v208, v124, v125
    v_cvt_pk_bf16_f32 v209, v126, v127
    v_exp_f32 v128, v128
    v_exp_f32 v129, v129
    v_exp_f32 v130, v130
    v_exp_f32 v131, v131
    v_cvt_pk_bf16_f32 v210, v128, v129
    v_cvt_pk_bf16_f32 v211, v130, v131
    v_mfma_f32_32x32x16_bf16 v[116:131], v[212:215], v[24:27], v[84:99]
    v_exp_f32 v100, v100
    v_exp_f32 v101, v101
    v_exp_f32 v102, v102
    v_exp_f32 v103, v103
    v_mfma_f32_32x32x8bf16_1k v[116:131], v[220:221], v[34:35], v[116:131]
    v_cvt_pk_bf16_f32 v196, v100, v101
    v_cvt_pk_bf16_f32 v197, v102, v103
    v_exp_f32 v104, v104
    v_exp_f32 v105, v105
    v_exp_f32 v106, v106
    v_exp_f32 v107, v107
    v_mfma_f32_32x32x16_bf16 v[148:163], v[224:227], v[204:207], v[148:163]
    v_cvt_pk_bf16_f32 v198, v104, v105
    v_cvt_pk_bf16_f32 v199, v106, v107
    v_exp_f32 v108, v108
    v_exp_f32 v109, v109
    v_exp_f32 v110, v110
    v_exp_f32 v111, v111
    v_mfma_f32_32x32x16_bf16 v[148:163], v[228:231], v[208:211], v[148:163]
    s_waitcnt lgkmcnt(2)
    v_cvt_pk_bf16_f32 v200, v108, v109
    v_cvt_pk_bf16_f32 v201, v110, v111
    v_exp_f32 v112, v112
    v_exp_f32 v113, v113
    v_exp_f32 v114, v114
    v_exp_f32 v115, v115
    v_cvt_pk_bf16_f32 v202, v112, v113
    v_cvt_pk_bf16_f32 v203, v114, v115
    v_mfma_f32_32x32x16_bf16 v[100:115], v[216:219], v[12:15], v[36:51]
    v_exp_f32 v116, v116
    v_exp_f32 v117, v117
    v_exp_f32 v118, v118
    v_exp_f32 v119, v119
    v_mfma_f32_32x32x8bf16_1k v[100:115], v[222:223], v[28:29], v[100:115]
    v_cvt_pk_bf16_f32 v204, v116, v117
    v_cvt_pk_bf16_f32 v205, v118, v119
    v_exp_f32 v120, v120
    v_exp_f32 v121, v121
    v_exp_f32 v122, v122
    v_exp_f32 v123, v123
    v_mfma_f32_32x32x16_bf16 v[164:179], v[224:227], v[196:199], v[164:179]
    v_cvt_pk_bf16_f32 v206, v120, v121
    v_cvt_pk_bf16_f32 v207, v122, v123
    v_exp_f32 v124, v124
    v_exp_f32 v125, v125
    v_exp_f32 v126, v126
    v_exp_f32 v127, v127
    v_mfma_f32_32x32x16_bf16 v[164:179], v[228:231], v[200:203], v[164:179]
    v_cvt_pk_bf16_f32 v208, v124, v125
    v_cvt_pk_bf16_f32 v209, v126, v127
    v_exp_f32 v128, v128
    v_exp_f32 v129, v129
    v_exp_f32 v130, v130
    v_exp_f32 v131, v131
    v_cvt_pk_bf16_f32 v210, v128, v129
    v_cvt_pk_bf16_f32 v211, v130, v131
    v_mfma_f32_32x32x16_bf16 v[116:131], v[216:219], v[16:19], v[52:67]
    ds_read_b128 v[212:215], v6 offset:9216
    ds_read_b32 v220, v7 offset:1024
    v_exp_f32 v100, v100
    v_exp_f32 v101, v101
    v_exp_f32 v102, v102
    v_exp_f32 v103, v103
    v_mfma_f32_32x32x8bf16_1k v[116:131], v[222:223], v[30:31], v[116:131]
    v_cvt_pk_bf16_f32 v196, v100, v101
    v_cvt_pk_bf16_f32 v197, v102, v103
    v_exp_f32 v104, v104
    v_exp_f32 v105, v105
    v_exp_f32 v106, v106
    v_exp_f32 v107, v107
    v_mfma_f32_32x32x16_bf16 v[180:195], v[224:227], v[204:207], v[180:195]
    v_cvt_pk_bf16_f32 v198, v104, v105
    v_cvt_pk_bf16_f32 v199, v106, v107
    v_exp_f32 v108, v108
    v_exp_f32 v109, v109
    v_exp_f32 v110, v110
    v_exp_f32 v111, v111
    v_mfma_f32_32x32x16_bf16 v[180:195], v[228:231], v[208:211], v[180:195]
    s_waitcnt lgkmcnt(2)
    v_cvt_pk_bf16_f32 v200, v108, v109
    v_cvt_pk_bf16_f32 v201, v110, v111
    v_exp_f32 v112, v112
    v_exp_f32 v113, v113
    v_exp_f32 v114, v114
    v_exp_f32 v115, v115
    v_cvt_pk_bf16_f32 v202, v112, v113
    v_cvt_pk_bf16_f32 v203, v114, v115
    v_mfma_f32_32x32x16_bf16 v[100:115], v[216:219], v[20:23], v[68:83]
    s_mov_b64 exec, s[30:31]
    ds_read_b128 v[224:227], v8 offset:9216
    ds_read_b128 v[228:231], v8 offset:9856
    s_mov_b64 exec, -1
    v_exp_f32 v116, v116
    v_exp_f32 v117, v117
    v_exp_f32 v118, v118
    v_exp_f32 v119, v119
    v_mfma_f32_32x32x8bf16_1k v[100:115], v[222:223], v[32:33], v[100:115]
    v_cvt_pk_bf16_f32 v204, v116, v117
    v_cvt_pk_bf16_f32 v205, v118, v119
    v_exp_f32 v120, v120
    v_exp_f32 v121, v121
    v_exp_f32 v122, v122
    v_exp_f32 v123, v123
    v_mfma_f32_32x32x16_bf16 v[132:147], v[232:235], v[196:199], v[132:147]
    v_cvt_pk_bf16_f32 v206, v120, v121
    v_cvt_pk_bf16_f32 v207, v122, v123
    v_exp_f32 v124, v124
    v_exp_f32 v125, v125
    v_exp_f32 v126, v126
    v_exp_f32 v127, v127
    v_mfma_f32_32x32x16_bf16 v[132:147], v[236:239], v[200:203], v[132:147]
    v_cvt_pk_bf16_f32 v208, v124, v125
    v_cvt_pk_bf16_f32 v209, v126, v127
    v_exp_f32 v128, v128
    v_exp_f32 v129, v129
    v_exp_f32 v130, v130
    v_exp_f32 v131, v131
    v_cvt_pk_bf16_f32 v210, v128, v129
    v_cvt_pk_bf16_f32 v211, v130, v131
    v_mfma_f32_32x32x16_bf16 v[116:131], v[216:219], v[24:27], v[84:99]
    v_exp_f32 v100, v100
    v_exp_f32 v101, v101
    v_exp_f32 v102, v102
    v_exp_f32 v103, v103
    v_mfma_f32_32x32x8bf16_1k v[116:131], v[222:223], v[34:35], v[116:131]
    v_add_u32 v6, 9216, v6
    v_add_u32 v7, 1024, v7
    v_add_u32 v8, 9216, v8
    v_cvt_pk_bf16_f32 v196, v100, v101
    v_cvt_pk_bf16_f32 v197, v102, v103
    v_exp_f32 v104, v104
    v_exp_f32 v105, v105
    v_exp_f32 v106, v106
    v_exp_f32 v107, v107
    v_mfma_f32_32x32x16_bf16 v[148:163], v[232:235], v[204:207], v[148:163]
    v_cvt_pk_bf16_f32 v198, v104, v105
    v_cvt_pk_bf16_f32 v199, v106, v107
    v_exp_f32 v108, v108
    v_exp_f32 v109, v109
    v_exp_f32 v110, v110
    v_exp_f32 v111, v111
    v_mfma_f32_32x32x16_bf16 v[148:163], v[236:239], v[208:211], v[148:163]
    s_waitcnt lgkmcnt(2)
    v_cvt_pk_bf16_f32 v200, v108, v109
    v_cvt_pk_bf16_f32 v201, v110, v111
    v_exp_f32 v112, v112
    v_exp_f32 v113, v113
    v_exp_f32 v114, v114
    v_exp_f32 v115, v115
    v_cvt_pk_bf16_f32 v202, v112, v113
    v_cvt_pk_bf16_f32 v203, v114, v115
    v_mfma_f32_32x32x16_bf16 v[100:115], v[212:215], v[12:15], v[36:51]
    s_add_u32 s24, s24, 1
    v_exp_f32 v116, v116
    v_exp_f32 v117, v117
    v_exp_f32 v118, v118
    v_exp_f32 v119, v119
    v_mfma_f32_32x32x8bf16_1k v[100:115], v[220:221], v[28:29], v[100:115]
    v_cvt_pk_bf16_f32 v204, v116, v117
    v_cvt_pk_bf16_f32 v205, v118, v119
    v_exp_f32 v120, v120
    v_exp_f32 v121, v121
    v_exp_f32 v122, v122
    v_exp_f32 v123, v123
    v_mfma_f32_32x32x16_bf16 v[164:179], v[232:235], v[196:199], v[164:179]
    s_cmp_lg_u32 s24, s25
    v_cvt_pk_bf16_f32 v206, v120, v121
    v_cvt_pk_bf16_f32 v207, v122, v123
    v_exp_f32 v124, v124
    v_exp_f32 v125, v125
    v_exp_f32 v126, v126
    v_exp_f32 v127, v127
    v_mfma_f32_32x32x16_bf16 v[164:179], v[236:239], v[200:203], v[164:179]
    v_cvt_pk_bf16_f32 v208, v124, v125
    v_cvt_pk_bf16_f32 v209, v126, v127
    v_exp_f32 v128, v128
    v_exp_f32 v129, v129
    v_exp_f32 v130, v130
    v_exp_f32 v131, v131
    v_cvt_pk_bf16_f32 v210, v128, v129
    v_cvt_pk_bf16_f32 v211, v130, v131
    s_cbranch_scc1 P2_LOOP
    s_cmp_eq_u32 s24, 15
    s_cbranch_scc1 P2_LAST
    s_barrier
    s_cmp_eq_u32 s24, 3
    s_cselect_b32 s25, 12, 15
    s_cmp_eq_u32 s24, 1
    s_cselect_b32 s25, 3, s25
    s_branch P2_LOOP
P2_EV1:
    s_cmp_eq_u32 s24, 15
    s_cbranch_scc1 P2_LAST
    s_barrier
    s_cmp_eq_u32 s24, 3
    s_cselect_b32 s25, 12, 15
    s_cmp_eq_u32 s24, 1
    s_cselect_b32 s25, 3, s25
    s_branch P2_BK1
.p2align 6
P2_LAST:
    s_barrier
    v_mfma_f32_32x32x16_bf16 v[116:131], v[212:215], v[16:19], v[52:67]
    ds_read_b128 v[216:219], v6 offset:6912
    ds_read_b32 v222, v7 offset:768
    v_exp_f32 v100, v100
    v_exp_f32 v101, v101
    v_exp_f32 v102, v102
    v_exp_f32 v103, v103
    v_mfma_f32_32x32x8bf16_1k v[116:131], v[220:221], v[30:31], v[116:131]
    v_cvt_pk_bf16_f32 v196, v100, v101
    v_cvt_pk_bf16_f32 v197, v102, v103
    v_exp_f32 v104, v104
    v_exp_f32 v105, v105
    v_exp_f32 v106, v106
    v_exp_f32 v107, v107
    v_mfma_f32_32x32x16_bf16 v[180:195], v[232:235], v[204:207], v[180:195]
    v_cvt_pk_bf16_f32 v198, v104, v105
    v_cvt_pk_bf16_f32 v199, v106, v107
    v_exp_f32 v108, v108
    v_exp_f32 v109, v109
    v_exp_f32 v110, v110
    v_exp_f32 v111, v111
    v_mfma_f32_32x32x16_bf16 v[180:195], v[236:239], v[208:211], v[180:195]
    s_waitcnt lgkmcnt(2)
    v_cvt_pk_bf16_f32 v200, v108, v109
    v_cvt_pk_bf16_f32 v201, v110, v111
    v_exp_f32 v112, v112
    v_exp_f32 v113, v113
    v_exp_f32 v114, v114
    v_exp_f32 v115, v115
    v_cvt_pk_bf16_f32 v202, v112, v113
    v_cvt_pk_bf16_f32 v203, v114, v115
    v_mfma_f32_32x32x16_bf16 v[100:115], v[212:215], v[20:23], v[68:83]
    s_mov_b64 exec, s[30:31]
    ds_read_b128 v[232:235], v8 offset:6912
    ds_read_b128 v[236:239], v8 offset:7552
    s_mov_b64 exec, -1
    v_exp_f32 v116, v116
    v_exp_f32 v117, v117
    v_exp_f32 v118, v118
    v_exp_f32 v119, v119
    v_mfma_f32_32x32x8bf16_1k v[100:115], v[220:221], v[32:33], v[100:115]
    v_cvt_pk_bf16_f32 v204, v116, v117
    v_cvt_pk_bf16_f32 v205, v118, v119
    v_exp_f32 v120, v120
    v_exp_f32 v121, v121
    v_exp_f32 v122, v122
    v_exp_f32 v123, v123
    v_mfma_f32_32x32x16_bf16 v[132:147], v[224:227], v[196:199], v[132:147]
    v_cvt_pk_bf16_f32 v206, v120, v121
    v_cvt_pk_bf16_f32 v207, v122, v123
    v_exp_f32 v124, v124
    v_exp_f32 v125, v125
    v_exp_f32 v126, v126
    v_exp_f32 v127, v127
    v_mfma_f32_32x32x16_bf16 v[132:147], v[228:231], v[200:203], v[132:147]
    v_cvt_pk_bf16_f32 v208, v124, v125
    v_cvt_pk_bf16_f32 v209, v126, v127
    v_exp_f32 v128, v128
    v_exp_f32 v129, v129
    v_exp_f32 v130, v130
    v_exp_f32 v131, v131
    v_cvt_pk_bf16_f32 v210, v128, v129
    v_cvt_pk_bf16_f32 v211, v130, v131
    v_mfma_f32_32x32x16_bf16 v[116:131], v[212:215], v[24:27], v[84:99]
    v_exp_f32 v100, v100
    v_exp_f32 v101, v101
    v_exp_f32 v102, v102
    v_exp_f32 v103, v103
    v_mfma_f32_32x32x8bf16_1k v[116:131], v[220:221], v[34:35], v[116:131]
    v_cvt_pk_bf16_f32 v196, v100, v101
    v_cvt_pk_bf16_f32 v197, v102, v103
    v_exp_f32 v104, v104
    v_exp_f32 v105, v105
    v_exp_f32 v106, v106
    v_exp_f32 v107, v107
    v_mfma_f32_32x32x16_bf16 v[148:163], v[224:227], v[204:207], v[148:163]
    v_cvt_pk_bf16_f32 v198, v104, v105
    v_cvt_pk_bf16_f32 v199, v106, v107
    v_exp_f32 v108, v108
    v_exp_f32 v109, v109
    v_exp_f32 v110, v110
    v_exp_f32 v111, v111
    v_mfma_f32_32x32x16_bf16 v[148:163], v[228:231], v[208:211], v[148:163]
    s_waitcnt lgkmcnt(2)
    v_cvt_pk_bf16_f32 v200, v108, v109
    v_cvt_pk_bf16_f32 v201, v110, v111
    v_exp_f32 v112, v112
    v_exp_f32 v113, v113
    v_exp_f32 v114, v114
    v_exp_f32 v115, v115
    v_cvt_pk_bf16_f32 v202, v112, v113
    v_cvt_pk_bf16_f32 v203, v114, v115
    v_mfma_f32_32x32x16_bf16 v[100:115], v[216:219], v[12:15], v[36:51]
    v_exp_f32 v116, v116
    v_exp_f32 v117, v117
    v_exp_f32 v118, v118
    v_exp_f32 v119, v119
    v_mfma_f32_32x32x8bf16_1k v[100:115], v[222:223], v[28:29], v[100:115]
    v_cvt_pk_bf16_f32 v204, v116, v117
    v_cvt_pk_bf16_f32 v205, v118, v119
    v_exp_f32 v120, v120
    v_exp_f32 v121, v121
    v_exp_f32 v122, v122
    v_exp_f32 v123, v123
    v_mfma_f32_32x32x16_bf16 v[164:179], v[224:227], v[196:199], v[164:179]
    v_cvt_pk_bf16_f32 v206, v120, v121
    v_cvt_pk_bf16_f32 v207, v122, v123
    v_exp_f32 v124, v124
    v_exp_f32 v125, v125
    v_exp_f32 v126, v126
    v_exp_f32 v127, v127
    v_mfma_f32_32x32x16_bf16 v[164:179], v[228:231], v[200:203], v[164:179]
    v_cvt_pk_bf16_f32 v208, v124, v125
    v_cvt_pk_bf16_f32 v209, v126, v127
    v_exp_f32 v128, v128
    v_exp_f32 v129, v129
    v_exp_f32 v130, v130
    v_exp_f32 v131, v131
    v_cvt_pk_bf16_f32 v210, v128, v129
    v_cvt_pk_bf16_f32 v211, v130, v131
    v_mfma_f32_32x32x16_bf16 v[116:131], v[216:219], v[16:19], v[52:67]
    v_exp_f32 v100, v100
    v_exp_f32 v101, v101
    v_exp_f32 v102, v102
    v_exp_f32 v103, v103
    v_mfma_f32_32x32x8bf16_1k v[116:131], v[222:223], v[30:31], v[116:131]
    v_cvt_pk_bf16_f32 v196, v100, v101
    v_cvt_pk_bf16_f32 v197, v102, v103
    v_exp_f32 v104, v104
    v_exp_f32 v105, v105
    v_exp_f32 v106, v106
    v_exp_f32 v107, v107
    v_mfma_f32_32x32x16_bf16 v[180:195], v[224:227], v[204:207], v[180:195]
    v_cvt_pk_bf16_f32 v198, v104, v105
    v_cvt_pk_bf16_f32 v199, v106, v107
    v_exp_f32 v108, v108
    v_exp_f32 v109, v109
    v_exp_f32 v110, v110
    v_exp_f32 v111, v111
    v_mfma_f32_32x32x16_bf16 v[180:195], v[228:231], v[208:211], v[180:195]
    s_waitcnt lgkmcnt(0)
    v_cvt_pk_bf16_f32 v200, v108, v109
    v_cvt_pk_bf16_f32 v201, v110, v111
    v_exp_f32 v112, v112
    v_exp_f32 v113, v113
    v_exp_f32 v114, v114
    v_exp_f32 v115, v115
    v_cvt_pk_bf16_f32 v202, v112, v113
    v_cvt_pk_bf16_f32 v203, v114, v115
    v_mfma_f32_32x32x16_bf16 v[100:115], v[216:219], v[20:23], v[68:83]
    v_exp_f32 v116, v116
    v_exp_f32 v117, v117
    v_exp_f32 v118, v118
    v_exp_f32 v119, v119
    v_mfma_f32_32x32x8bf16_1k v[100:115], v[222:223], v[32:33], v[100:115]
    v_cvt_pk_bf16_f32 v204, v116, v117
    v_cvt_pk_bf16_f32 v205, v118, v119
    v_exp_f32 v120, v120
    v_exp_f32 v121, v121
    v_exp_f32 v122, v122
    v_exp_f32 v123, v123
    v_mfma_f32_32x32x16_bf16 v[132:147], v[232:235], v[196:199], v[132:147]
    v_cvt_pk_bf16_f32 v206, v120, v121
    v_cvt_pk_bf16_f32 v207, v122, v123
    v_exp_f32 v124, v124
    v_exp_f32 v125, v125
    v_exp_f32 v126, v126
    v_exp_f32 v127, v127
    v_mfma_f32_32x32x16_bf16 v[132:147], v[236:239], v[200:203], v[132:147]
    v_cvt_pk_bf16_f32 v208, v124, v125
    v_cvt_pk_bf16_f32 v209, v126, v127
    v_exp_f32 v128, v128
    v_exp_f32 v129, v129
    v_exp_f32 v130, v130
    v_exp_f32 v131, v131
    v_cvt_pk_bf16_f32 v210, v128, v129
    v_cvt_pk_bf16_f32 v211, v130, v131
    v_mfma_f32_32x32x16_bf16 v[116:131], v[216:219], v[24:27], v[84:99]
    v_exp_f32 v100, v100
    v_exp_f32 v101, v101
    v_exp_f32 v102, v102
    v_exp_f32 v103, v103
    v_mfma_f32_32x32x8bf16_1k v[116:131], v[222:223], v[34:35], v[116:131]
    v_cvt_pk_bf16_f32 v196, v100, v101
    v_cvt_pk_bf16_f32 v197, v102, v103
    v_exp_f32 v104, v104
    v_exp_f32 v105, v105
    v_exp_f32 v106, v106
    v_exp_f32 v107, v107
    v_mfma_f32_32x32x16_bf16 v[148:163], v[232:235], v[204:207], v[148:163]
    ds_write_b128 v11, v[132:135] offset:0
    ds_write_b128 v11, v[136:139] offset:1024
    v_cvt_pk_bf16_f32 v198, v104, v105
    v_cvt_pk_bf16_f32 v199, v106, v107
    v_exp_f32 v108, v108
    v_exp_f32 v109, v109
    v_exp_f32 v110, v110
    v_exp_f32 v111, v111
    v_mfma_f32_32x32x16_bf16 v[148:163], v[236:239], v[208:211], v[148:163]
    ds_write_b128 v11, v[140:143] offset:2048
    ds_write_b32 v11, v144 offset:3072
    v_cvt_pk_bf16_f32 v200, v108, v109
    v_cvt_pk_bf16_f32 v201, v110, v111
    v_exp_f32 v112, v112
    v_exp_f32 v113, v113
    v_exp_f32 v114, v114
    v_exp_f32 v115, v115
    v_cvt_pk_bf16_f32 v202, v112, v113
    v_cvt_pk_bf16_f32 v203, v114, v115
    v_exp_f32 v116, v116
    v_exp_f32 v117, v117
    v_exp_f32 v118, v118
    v_exp_f32 v119, v119
    v_cvt_pk_bf16_f32 v204, v116, v117
    v_cvt_pk_bf16_f32 v205, v118, v119
    v_exp_f32 v120, v120
    v_exp_f32 v121, v121
    v_exp_f32 v122, v122
    v_exp_f32 v123, v123
    v_mfma_f32_32x32x16_bf16 v[164:179], v[232:235], v[196:199], v[164:179]
    ds_write_b128 v11, v[148:151] offset:4096
    ds_write_b128 v11, v[152:155] offset:5120
    v_cvt_pk_bf16_f32 v206, v120, v121
    v_cvt_pk_bf16_f32 v207, v122, v123
    v_exp_f32 v124, v124
    v_exp_f32 v125, v125
    v_exp_f32 v126, v126
    v_exp_f32 v127, v127
    v_mfma_f32_32x32x16_bf16 v[164:179], v[236:239], v[200:203], v[164:179]
    ds_write_b128 v11, v[156:159] offset:6144
    ds_write_b32 v11, v160 offset:7168
    v_cvt_pk_bf16_f32 v208, v124, v125
    v_cvt_pk_bf16_f32 v209, v126, v127
    v_exp_f32 v128, v128
    v_exp_f32 v129, v129
    v_exp_f32 v130, v130
    v_exp_f32 v131, v131
    v_cvt_pk_bf16_f32 v210, v128, v129
    v_cvt_pk_bf16_f32 v211, v130, v131
    v_mfma_f32_32x32x16_bf16 v[180:195], v[232:235], v[204:207], v[180:195]
    s_nop 0
    v_mfma_f32_32x32x16_bf16 v[180:195], v[236:239], v[208:211], v[180:195]
    s_waitcnt lgkmcnt(0)
    s_barrier
    ds_read_b128 v[100:103], v3 offset:0
    ds_read_b128 v[104:107], v3 offset:1024
    ds_read_b128 v[108:111], v3 offset:2048
    ds_read_b32 v112, v3 offset:3072
    ds_read_b128 v[116:119], v3 offset:4096
    ds_read_b128 v[120:123], v3 offset:5120
    ds_read_b128 v[124:127], v3 offset:6144
    ds_read_b32 v128, v3 offset:7168
    s_mov_b32 s16, 32768
    s_mov_b32 s17, 8192
    s_waitcnt lgkmcnt(4)
    v_add_f32 v176, v176, v112
    v_rcp_f32 v178, v176
    v_pk_add_f32 v[164:165], v[164:165], v[100:101]
    v_pk_add_f32 v[166:167], v[166:167], v[102:103]
    v_pk_add_f32 v[168:169], v[168:169], v[104:105]
    v_pk_add_f32 v[170:171], v[170:171], v[106:107]
    v_pk_add_f32 v[172:173], v[172:173], v[108:109]
    v_pk_add_f32 v[174:175], v[174:175], v[110:111]
    v_pk_mul_f32 v[100:101], v[164:165], v[178:179] op_sel_hi:[1,0]
    v_pk_mul_f32 v[102:103], v[166:167], v[178:179] op_sel_hi:[1,0]
    v_pk_mul_f32 v[104:105], v[168:169], v[178:179] op_sel_hi:[1,0]
    v_pk_mul_f32 v[106:107], v[170:171], v[178:179] op_sel_hi:[1,0]
    v_pk_mul_f32 v[108:109], v[172:173], v[178:179] op_sel_hi:[1,0]
    v_pk_mul_f32 v[110:111], v[174:175], v[178:179] op_sel_hi:[1,0]
    v_cvt_pk_bf16_f32 v196, v100, v101
    v_cvt_pk_bf16_f32 v197, v102, v103
    v_cvt_pk_bf16_f32 v198, v104, v105
    v_cvt_pk_bf16_f32 v199, v106, v107
    v_cvt_pk_bf16_f32 v200, v108, v109
    v_cvt_pk_bf16_f32 v201, v110, v111
    buffer_store_dwordx4 v[196:199], v9, s[60:63], 0 offen sc1
    buffer_store_dwordx2 v[200:201], v10, s[60:63], 0 offen sc1
    s_waitcnt lgkmcnt(0)
    v_add_f32 v192, v192, v128
    v_rcp_f32 v194, v192
    v_pk_add_f32 v[180:181], v[180:181], v[116:117]
    v_pk_add_f32 v[182:183], v[182:183], v[118:119]
    v_pk_add_f32 v[184:185], v[184:185], v[120:121]
    v_pk_add_f32 v[186:187], v[186:187], v[122:123]
    v_pk_add_f32 v[188:189], v[188:189], v[124:125]
    v_pk_add_f32 v[190:191], v[190:191], v[126:127]
    v_pk_mul_f32 v[116:117], v[180:181], v[194:195] op_sel_hi:[1,0]
    v_pk_mul_f32 v[118:119], v[182:183], v[194:195] op_sel_hi:[1,0]
    v_pk_mul_f32 v[120:121], v[184:185], v[194:195] op_sel_hi:[1,0]
    v_pk_mul_f32 v[122:123], v[186:187], v[194:195] op_sel_hi:[1,0]
    v_pk_mul_f32 v[124:125], v[188:189], v[194:195] op_sel_hi:[1,0]
    v_pk_mul_f32 v[126:127], v[190:191], v[194:195] op_sel_hi:[1,0]
    v_cvt_pk_bf16_f32 v204, v116, v117
    v_cvt_pk_bf16_f32 v205, v118, v119
    v_cvt_pk_bf16_f32 v206, v120, v121
    v_cvt_pk_bf16_f32 v207, v122, v123
    v_cvt_pk_bf16_f32 v208, v124, v125
    v_cvt_pk_bf16_f32 v209, v126, v127
    buffer_store_dwordx4 v[204:207], v9, s[60:63], s16 offen sc1
    buffer_store_dwordx2 v[208:209], v10, s[60:63], s17 offen sc1
    s_cmp_lg_u32 s26, 0
    s_cbranch_scc1 P2_PUB
    v_add_f32 v4, abs(v164), abs(v165)
    v_add_f32 v5, abs(v180), abs(v181)
    v_add_f32 v4, v4, abs(v166)
    v_add_f32 v5, v5, abs(v182)
    v_add_f32 v4, v4, abs(v167)
    v_add_f32 v5, v5, abs(v183)
    v_add_f32 v4, v4, abs(v168)
    v_add_f32 v5, v5, abs(v184)
    v_add_f32 v4, v4, abs(v169)
    v_add_f32 v5, v5, abs(v185)
    v_add_f32 v4, v4, abs(v170)
    v_add_f32 v5, v5, abs(v186)
    v_add_f32 v4, v4, abs(v171)
    v_add_f32 v5, v5, abs(v187)
    v_add_f32 v4, v4, abs(v172)
    v_add_f32 v5, v5, abs(v188)
    v_add_f32 v4, v4, abs(v173)
    v_add_f32 v5, v5, abs(v189)
    v_add_f32 v4, v4, abs(v174)
    v_add_f32 v5, v5, abs(v190)
    v_add_f32 v4, v4, abs(v175)
    v_add_f32 v5, v5, abs(v191)
    s_mov_b32 s16, 0x5f800000
    s_mov_b32 s17, 0x7b800000
    v_add_f32 v4, v4, v5
    v_add_f32 v5, v176, v192
    v_cmp_nle_f32 s[18:19], v5, s16
    v_cmp_nle_f32 vcc, v4, s17
    s_nop 0
    s_or_b64 s[18:19], s[18:19], vcc
    s_cselect_b32 s16, 1, 0
    s_lshl_b32 s17, s3, 2
    s_add_u32 s17, s17, 133120
    v_mov_b32 v2, s16
    v_mov_b32 v3, s17
    ds_write_b32 v3, v2
    v_mov_b32 v3, 133120
    s_waitcnt lgkmcnt(0)
    s_barrier
    ds_read_b128 v[100:103], v3
    s_waitcnt lgkmcnt(0)
    v_or3_b32 v2, v100, v101, v102
    v_or_b32 v2, v2, v103
    s_nop 0
    v_readfirstlane_b32 s16, v2
    s_nop 0
    s_cmp_lg_u32 s16, 0
    s_cbranch_scc1 P2_EXACT
P2_PUB:
    s_lshl_b32 s16, s52, 5
    s_add_u32 s16, s16, s20
    s_lshl_b32 s16, s16, 8
    s_add_u32 s16, s16, 10616832
    s_waitcnt vmcnt(0)
    v_mov_b32 v2, 1
    s_mov_b64 exec, 1
    buffer_store_dword v2, off, s[60:63], s16 offset:0 sc1
    s_mov_b64 exec, -1
    s_endpgm
P2_EXACT:
    s_mov_b32 s26, 1
    v_and_b32 v2, 31, v0
    v_mov_b32 v6, v1
    v_lshlrev_b32 v7, 3, v2
    v_add_u32 v7, 73728, v7
    v_lshrrev_b32 v2, 5, v0
    v_lshl_add_u32 v7, v2, 2, v7
    v_mov_b32 v240, 0xff800000
    v_mov_b32 v241, 0xff800000
    v_mov_b32 v242, 0xff800000
    v_mov_b32 v243, 0xff800000
    s_waitcnt vmcnt(0)
    s_barrier
    s_barrier
    s_mov_b32 s24, 0
P2_MAXL:
    ds_read_b128 v[212:215], v6
    ds_read_b32 v220, v7
    s_cmp_eq_u32 s24, 31
    s_cselect_b32 s16, 8192, 0
    s_cselect_b32 s17, 73728, 0
    s_add_u32 s16, s16, 2304
    s_add_u32 s17, s17, 256
    v_add_u32 v6, s16, v6
    v_add_u32 v7, s17, v7
    s_waitcnt lgkmcnt(0)
    v_mfma_f32_32x32x16_bf16 v[36:51], v[212:215], v[12:15], 0
    v_mfma_f32_32x32x8bf16_1k v[36:51], v[220:221], v[28:29], v[36:51]
    v_mfma_f32_32x32x16_bf16 v[52:67], v[212:215], v[16:19], 0
    v_mfma_f32_32x32x8bf16_1k v[52:67], v[220:221], v[30:31], v[52:67]
    v_mfma_f32_32x32x16_bf16 v[68:83], v[212:215], v[20:23], 0
    v_mfma_f32_32x32x8bf16_1k v[68:83], v[220:221], v[32:33], v[68:83]
    v_mfma_f32_32x32x16_bf16 v[84:99], v[212:215], v[24:27], 0
    v_mfma_f32_32x32x8bf16_1k v[84:99], v[220:221], v[34:35], v[84:99]
    s_nop 5
    v_max3_f32 v240, v240, v36, v37
    v_max3_f32 v240, v240, v38, v39
    v_max3_f32 v240, v240, v40, v41
    v_max3_f32 v240, v240, v42, v43
    v_max3_f32 v240, v240, v44, v45
    v_max3_f32 v240, v240, v46, v47
    v_max3_f32 v240, v240, v48, v49
    v_max3_f32 v240, v240, v50, v51
    v_max3_f32 v241, v241, v52, v53
    v_max3_f32 v241, v241, v54, v55
    v_max3_f32 v241, v241, v56, v57
    v_max3_f32 v241, v241, v58, v59
    v_max3_f32 v241, v241, v60, v61
    v_max3_f32 v241, v241, v62, v63
    v_max3_f32 v241, v241, v64, v65
    v_max3_f32 v241, v241, v66, v67
    v_max3_f32 v242, v242, v68, v69
    v_max3_f32 v242, v242, v70, v71
    v_max3_f32 v242, v242, v72, v73
    v_max3_f32 v242, v242, v74, v75
    v_max3_f32 v242, v242, v76, v77
    v_max3_f32 v242, v242, v78, v79
    v_max3_f32 v242, v242, v80, v81
    v_max3_f32 v242, v242, v82, v83
    v_max3_f32 v243, v243, v84, v85
    v_max3_f32 v243, v243, v86, v87
    v_max3_f32 v243, v243, v88, v89
    v_max3_f32 v243, v243, v90, v91
    v_max3_f32 v243, v243, v92, v93
    v_max3_f32 v243, v243, v94, v95
    v_max3_f32 v243, v243, v96, v97
    v_max3_f32 v243, v243, v98, v99
    s_add_u32 s24, s24, 1
    s_cmp_lt_u32 s24, 64
    s_cbranch_scc1 P2_MAXL
    v_mov_b32 v2, v240
    v_mov_b32 v3, v241
    v_mov_b32 v4, v242
    v_mov_b32 v5, v243
    v_permlane32_swap_b32 v240, v2
    v_permlane32_swap_b32 v241, v3
    v_permlane32_swap_b32 v242, v4
    v_permlane32_swap_b32 v243, v5
    v_max_f32 v240, v240, v2
    v_max_f32 v241, v241, v3
    v_max_f32 v242, v242, v4
    v_max_f32 v243, v243, v5
    v_xor_b32 v36, 0x80000000, v240
    v_xor_b32 v52, 0x80000000, v241
    v_xor_b32 v68, 0x80000000, v242
    v_xor_b32 v84, 0x80000000, v243
    v_xor_b32 v37, 0x80000000, v240
    v_xor_b32 v53, 0x80000000, v241
    v_xor_b32 v69, 0x80000000, v242
    v_xor_b32 v85, 0x80000000, v243
    v_pk_mov_b32 v[38:39], v[36:37], v[36:37]
    v_pk_mov_b32 v[54:55], v[52:53], v[52:53]
    v_pk_mov_b32 v[70:71], v[68:69], v[68:69]
    v_pk_mov_b32 v[86:87], v[84:85], v[84:85]
    v_pk_mov_b32 v[40:41], v[36:37], v[36:37]
    v_pk_mov_b32 v[56:57], v[52:53], v[52:53]
    v_pk_mov_b32 v[72:73], v[68:69], v[68:69]
    v_pk_mov_b32 v[88:89], v[84:85], v[84:85]
    v_pk_mov_b32 v[42:43], v[36:37], v[36:37]
    v_pk_mov_b32 v[58:59], v[52:53], v[52:53]
    v_pk_mov_b32 v[74:75], v[68:69], v[68:69]
    v_pk_mov_b32 v[90:91], v[84:85], v[84:85]
    v_pk_mov_b32 v[44:45], v[36:37], v[36:37]
    v_pk_mov_b32 v[60:61], v[52:53], v[52:53]
    v_pk_mov_b32 v[76:77], v[68:69], v[68:69]
    v_pk_mov_b32 v[92:93], v[84:85], v[84:85]
    v_pk_mov_b32 v[46:47], v[36:37], v[36:37]
    v_pk_mov_b32 v[62:63], v[52:53], v[52:53]
    v_pk_mov_b32 v[78:79], v[68:69], v[68:69]
    v_pk_mov_b32 v[94:95], v[84:85], v[84:85]
    v_pk_mov_b32 v[48:49], v[36:37], v[36:37]
    v_pk_mov_b32 v[64:65], v[52:53], v[52:53]
    v_pk_mov_b32 v[80:81], v[68:69], v[68:69]
    v_pk_mov_b32 v[96:97], v[84:85], v[84:85]
    v_pk_mov_b32 v[50:51], v[36:37], v[36:37]
    v_pk_mov_b32 v[66:67], v[52:53], v[52:53]
    v_pk_mov_b32 v[82:83], v[68:69], v[68:69]
    v_pk_mov_b32 v[98:99], v[84:85], v[84:85]
    s_mul_i32 s16, s23, 81920
    v_and_b32 v2, 31, v0
    v_lshrrev_b32 v4, 5, v0
    v_add_u32 v6, s16, v1
    s_add_u32 s17, s16, 73728
    v_lshl_add_u32 v7, v2, 3, s17
    v_lshl_add_u32 v7, v4, 2, v7
    v_mul_u32_u24 v8, 320, v4
    v_lshl_add_u32 v8, v2, 4, v8
    s_add_u32 s17, s16, 1024
    v_add_u32 v8, s17, v8
    v_mov_b32 v132, 0
    v_mov_b32 v133, 0
    v_pk_mov_b32 v[134:135], v[132:133], v[132:133]
    v_pk_mov_b32 v[136:137], v[132:133], v[132:133]
    v_pk_mov_b32 v[138:139], v[132:133], v[132:133]
    v_pk_mov_b32 v[140:141], v[132:133], v[132:133]
    v_pk_mov_b32 v[142:143], v[132:133], v[132:133]
    v_pk_mov_b32 v[144:145], v[132:133], v[132:133]
    v_pk_mov_b32 v[146:147], v[132:133], v[132:133]
    v_pk_mov_b32 v[148:149], v[132:133], v[132:133]
    v_pk_mov_b32 v[150:151], v[132:133], v[132:133]
    v_pk_mov_b32 v[152:153], v[132:133], v[132:133]
    v_pk_mov_b32 v[154:155], v[132:133], v[132:133]
    v_pk_mov_b32 v[156:157], v[132:133], v[132:133]
    v_pk_mov_b32 v[158:159], v[132:133], v[132:133]
    v_pk_mov_b32 v[160:161], v[132:133], v[132:133]
    v_pk_mov_b32 v[162:163], v[132:133], v[132:133]
    v_pk_mov_b32 v[164:165], v[132:133], v[132:133]
    v_pk_mov_b32 v[166:167], v[132:133], v[132:133]
    v_pk_mov_b32 v[168:169], v[132:133], v[132:133]
    v_pk_mov_b32 v[170:171], v[132:133], v[132:133]
    v_pk_mov_b32 v[172:173], v[132:133], v[132:133]
    v_pk_mov_b32 v[174:175], v[132:133], v[132:133]
    v_pk_mov_b32 v[176:177], v[132:133], v[132:133]
    v_pk_mov_b32 v[178:179], v[132:133], v[132:133]
    v_pk_mov_b32 v[180:181], v[132:133], v[132:133]
    v_pk_mov_b32 v[182:183], v[132:133], v[132:133]
    v_pk_mov_b32 v[184:185], v[132:133], v[132:133]
    v_pk_mov_b32 v[186:187], v[132:133], v[132:133]
    v_pk_mov_b32 v[188:189], v[132:133], v[132:133]
    v_pk_mov_b32 v[190:191], v[132:133], v[132:133]
    v_pk_mov_b32 v[192:193], v[132:133], v[132:133]
    v_pk_mov_b32 v[194:195], v[132:133], v[132:133]
    v_pk_mov_b32 v[204:205], v[132:133], v[132:133]
    v_pk_mov_b32 v[206:207], v[132:133], v[132:133]
    v_pk_mov_b32 v[208:209], v[132:133], v[132:133]
    v_pk_mov_b32 v[210:211], v[132:133], v[132:133]
    s_mov_b64 exec, s[30:31]
    v_mov_b32 v232, 0
    v_mov_b32 v233, 0
    v_mov_b32 v234, 0
    v_mov_b32 v235, 0
    v_mov_b32 v236, 0
    v_mov_b32 v237, 0
    v_mov_b32 v238, 0
    v_mov_b32 v239, 0
    s_mov_b64 exec, -1
    s_branch P2_MAIN
P2_PREP:
    s_and_b32 s16, s2, 7
    s_lshl_b32 s17, s16, 2
    s_lshr_b32 s18, s2, 3
    s_and_b32 s19, s18, 3
    s_add_u32 s20, s17, s19
    s_lshr_b32 s21, s2, 5
    s_lshr_b32 s17, s20, 1
    s_lshl_b32 s17, s17, 15
    s_and_b32 s19, s20, 1
    s_lshl_b32 s19, s19, 3
    s_add_u32 s51, s17, s19
    s_add_u32 s48, s51, 7340032
    s_mov_b32 s28, s20
    s_mov_b32 s29, s21
    s_mul_i32 s16, s16, 24
    s_add_u32 s27, s16, s18
    s_cmp_lt_u32 s18, 24
    s_cselect_b32 s27, s27, -1
    s_mov_b32 s26, 0
    s_sub_u32 s55, s3, 4
    s_lshl_b32 s22, s28, 2
    s_add_u32 s22, s22, s55
    s_lshl_b32 s12, s22, 4
    s_mul_i32 s13, s12, 1280
    s_mul_i32 s15, s29, 160
    s_add_u32 s56, s13, s15
    s_lshl_b32 s12, s12, 3
    s_add_u32 s12, s12, 10485760
    s_mul_i32 s14, s55, 5376
    s_add_u32 s14, s14, 53248
    s_mov_b32 s4, s64
    s_mov_b32 s5, s65
    s_mov_b32 s6, 2621440
    s_mov_b32 s7, 0x00020000
    v_add_u32 v2, 0, v0
    v_mul_u32_u24 v3, 205, v2
    v_lshrrev_b32 v3, 11, v3
    v_mul_u32_u24 v4, 1120, v3
    v_lshl_add_u32 v7, v2, 4, v4
    v_mov_b32 v12, v3
    v_mov_b32 v15, v7
    v_mul_u32_u24 v4, 10, v3
    v_sub_u32 v2, v2, v4
    v_lshlrev_b32 v21, 5, v2
    v_mul_u32_u24 v4, 336, v3
    v_add3_u32 v18, v4, v21, s14
    v_lshlrev_b32 v82, 3, v3
    buffer_load_dwordx4 v[64:67], v15, s[4:7], s56 offen
    v_add_u32 v2, 64, v0
    v_mul_u32_u24 v3, 205, v2
    v_lshrrev_b32 v3, 11, v3
    v_mul_u32_u24 v4, 1120, v3
    v_lshl_add_u32 v8, v2, 4, v4
    v_mov_b32 v13, v3
    v_mov_b32 v16, v8
    v_mul_u32_u24 v4, 10, v3
    v_sub_u32 v2, v2, v4
    v_lshlrev_b32 v22, 5, v2
    v_mul_u32_u24 v4, 336, v3
    v_add3_u32 v19, v4, v22, s14
    v_lshlrev_b32 v83, 3, v3
    buffer_load_dwordx4 v[68:71], v16, s[4:7], s56 offen
    v_add_u32 v2, 128, v0
    v_mul_u32_u24 v3, 205, v2
    v_lshrrev_b32 v3, 11, v3
    v_mul_u32_u24 v4, 1120, v3
    v_lshl_add_u32 v9, v2, 4, v4
    v_mov_b32 v14, v3
    v_mov_b32 v17, v9
    v_mul_u32_u24 v4, 10, v3
    v_sub_u32 v2, v2, v4
    v_lshlrev_b32 v23, 5, v2
    v_mul_u32_u24 v4, 336, v3
    v_add3_u32 v20, v4, v23, s14
    v_lshlrev_b32 v84, 3, v3
    v_lshrrev_b32 v4, 5, v0
    v_lshlrev_b32 v4, 30, v4
    v_add_u32 v17, v17, v4
    v_add_u32 v84, v84, v4
    v_lshl_add_u32 v31, v0, 2, v4
    buffer_load_dwordx4 v[72:75], v17, s[4:7], s56 offen
    v_add_u32 v2, 192, v0
    v_mul_u32_u24 v3, 205, v2
    v_lshrrev_b32 v3, 11, v3
    v_mul_u32_u24 v4, 1120, v3
    v_lshl_add_u32 v10, v2, 4, v4
    v_add_u32 v2, 256, v0
    v_mul_u32_u24 v3, 205, v2
    v_lshrrev_b32 v3, 11, v3
    v_mul_u32_u24 v4, 1120, v3
    v_lshl_add_u32 v11, v2, 4, v4
    s_cmp_eq_u32 s57, -1
    s_cbranch_scc1 P2_HELP0
    s_cmp_lg_u32 s3, 4
    s_cbranch_scc1 P2_HELP3
    v_lshlrev_b32 v2, 3, v0
    v_add_u32 v2, 131072, v2
    s_waitcnt vmcnt(3)
    v_xor_b32 v240, 0x80000000, v240
    v_xor_b32 v242, 0x80000000, v242
    ds_write2_b32 v2, v240, v242 offset0:0 offset1:1
    ds_write2_b32 v2, v241, v243 offset0:128 offset1:129
    s_waitcnt lgkmcnt(0)
P2_HELP3:
    s_barrier
P2_HELP0:
    buffer_load_dwordx2 v[76:77], v82, s[60:63], s12 offen sc1
    buffer_load_dwordx2 v[78:79], v83, s[60:63], s12 offen sc1
    buffer_load_dwordx2 v[80:81], v84, s[60:63], s12 offen sc1
P2_HELP2:
    v_lshrrev_b32 v6, 1, v0
    v_lshlrev_b32 v6, 4, v6
    v_and_b32 v3, 1, v0
    v_lshl_add_u32 v6, v3, 2, v6
    v_lshrrev_b32 v2, 4, v0
    v_bfe_u32 v3, v0, 2, 2
    v_and_b32 v4, 3, v0
    v_lshlrev_b32 v4, 3, v4
    v_mul_u32_u24 v35, 1280, v3
    v_lshl_add_u32 v35, v2, 5, v35
    v_add_u32 v35, v35, v4
    v_lshl_add_u32 v33, v2, 3, v3
    v_lshlrev_b32 v33, 4, v33
    v_cmp_eq_u32 vcc, v2, v3
    s_and_b32 s15, s55, 1
    s_mul_i32 s15, s15, 81920
    v_add_u32 v25, 81920, v1
    s_mov_b32 s15, 0
    v_add_u32 v24, s15, v1
    v_and_b32 v4, 3, v0
    v_min_u32 v4, 2, v4
    v_cndmask_b32 v4, 2, v4, vcc
    v_lshlrev_b32 v34, 4, v4
    v_add_u32 v34, 93440, v34
    v_and_b32 v4, 1, v0
    v_lshl_add_u32 v33, v4, 3, v33
    v_bfe_u32 v4, v0, 1, 1
    s_mov_b32 s16, 81920
    v_mul_u32_u24 v4, s16, v4
    v_add_u32 v33, v33, v4
    v_and_b32 v3, 15, v0
    v_cmp_lt_u32 vcc, 1, v3
    v_mul_u32_u24 v4, 1280, v3
    v_mov_b32 v5, 81920
    v_cndmask_b32 v4, v4, v5, vcc
    v_lshl_add_u32 v32, v2, 4, v4
    v_lshlrev_b32 v28, 8, v2
    v_lshl_add_u32 v28, v3, 3, v28
    v_mul_u32_u24 v29, 336, v3
    v_lshl_add_u32 v29, v2, 4, v29
    s_and_b32 s16, s55, 3
    s_mul_i32 s16, s16, 5376
    s_add_u32 s16, s16, s15
    s_add_u32 s16, s16, 53248
    v_add_u32 v29, s16, v29
    v_mul_u32_u24 v4, 86, v0
    v_lshrrev_b32 v4, 8, v4
    v_mul_u32_u24 v36, 2688, v4
    v_lshl_add_u32 v36, v0, 7, v36
    v_and_b32 v30, 31, v0
    v_lshlrev_b32 v30, 8, v30
    s_mul_i32 s17, s20, 147456
    s_add_u32 s17, s17, 2621440
    s_add_u32 s32, s84, s17
    s_addc_u32 s33, s85, 0
    s_mov_b32 s34, 147456
    s_mov_b32 s35, 0x00020000
    s_waitcnt vmcnt(0)
    v_lshlrev_b32 v40, 16, v64
    v_and_b32 v41, 0xffff0000, v64
    v_lshlrev_b32 v42, 16, v65
    v_and_b32 v43, 0xffff0000, v65
    v_lshlrev_b32 v44, 16, v66
    v_and_b32 v45, 0xffff0000, v66
    v_lshlrev_b32 v46, 16, v67
    v_and_b32 v47, 0xffff0000, v67
    v_pk_add_f32 v[88:89], v[40:41], v[76:77] op_sel_hi:[1,0] neg_lo:[0,1] neg_hi:[0,1]
    v_pk_add_f32 v[90:91], v[42:43], v[76:77] op_sel_hi:[1,0] neg_lo:[0,1] neg_hi:[0,1]
    v_pk_add_f32 v[92:93], v[44:45], v[76:77] op_sel_hi:[1,0] neg_lo:[0,1] neg_hi:[0,1]
    v_pk_add_f32 v[94:95], v[46:47], v[76:77] op_sel_hi:[1,0] neg_lo:[0,1] neg_hi:[0,1]
    v_cvt_pk_bf16_f32 v64, v88, v89
    v_cvt_pk_bf16_f32 v65, v90, v91
    v_cvt_pk_bf16_f32 v66, v92, v93
    v_cvt_pk_bf16_f32 v67, v94, v95
    v_lshlrev_b32 v88, 16, v64
    v_and_b32 v89, 0xffff0000, v64
    v_lshlrev_b32 v90, 16, v65
    v_and_b32 v91, 0xffff0000, v65
    v_lshlrev_b32 v92, 16, v66
    v_and_b32 v93, 0xffff0000, v66
    v_lshlrev_b32 v94, 16, v67
    v_and_b32 v95, 0xffff0000, v67
    v_pk_mul_f32 v[88:89], v[88:89], v[76:77] op_sel:[0,1] op_sel_hi:[1,1]
    v_pk_mul_f32 v[90:91], v[90:91], v[76:77] op_sel:[0,1] op_sel_hi:[1,1]
    v_pk_mul_f32 v[92:93], v[92:93], v[76:77] op_sel:[0,1] op_sel_hi:[1,1]
    v_pk_mul_f32 v[94:95], v[94:95], v[76:77] op_sel:[0,1] op_sel_hi:[1,1]
    v_cvt_pk_bf16_f32 v64, v88, v89
    v_cvt_pk_bf16_f32 v65, v90, v91
    v_cvt_pk_bf16_f32 v66, v92, v93
    v_cvt_pk_bf16_f32 v67, v94, v95
    v_lshlrev_b32 v88, 16, v64
    v_and_b32 v89, 0xffff0000, v64
    v_lshlrev_b32 v90, 16, v65
    v_and_b32 v91, 0xffff0000, v65
    v_lshlrev_b32 v92, 16, v66
    v_and_b32 v93, 0xffff0000, v66
    v_lshlrev_b32 v94, 16, v67
    v_and_b32 v95, 0xffff0000, v67
    v_pk_add_f32 v[40:41], v[40:41], v[88:89]
    v_pk_add_f32 v[42:43], v[42:43], v[90:91]
    v_pk_add_f32 v[44:45], v[44:45], v[92:93]
    v_pk_add_f32 v[46:47], v[46:47], v[94:95]
    v_lshlrev_b32 v48, 16, v68
    v_and_b32 v49, 0xffff0000, v68
    v_lshlrev_b32 v50, 16, v69
    v_and_b32 v51, 0xffff0000, v69
    v_lshlrev_b32 v52, 16, v70
    v_and_b32 v53, 0xffff0000, v70
    v_lshlrev_b32 v54, 16, v71
    v_and_b32 v55, 0xffff0000, v71
    v_pk_add_f32 v[88:89], v[48:49], v[78:79] op_sel_hi:[1,0] neg_lo:[0,1] neg_hi:[0,1]
    v_pk_add_f32 v[90:91], v[50:51], v[78:79] op_sel_hi:[1,0] neg_lo:[0,1] neg_hi:[0,1]
    v_pk_add_f32 v[92:93], v[52:53], v[78:79] op_sel_hi:[1,0] neg_lo:[0,1] neg_hi:[0,1]
    v_pk_add_f32 v[94:95], v[54:55], v[78:79] op_sel_hi:[1,0] neg_lo:[0,1] neg_hi:[0,1]
    v_cvt_pk_bf16_f32 v68, v88, v89
    v_cvt_pk_bf16_f32 v69, v90, v91
    v_cvt_pk_bf16_f32 v70, v92, v93
    v_cvt_pk_bf16_f32 v71, v94, v95
    v_lshlrev_b32 v88, 16, v68
    v_and_b32 v89, 0xffff0000, v68
    v_lshlrev_b32 v90, 16, v69
    v_and_b32 v91, 0xffff0000, v69
    v_lshlrev_b32 v92, 16, v70
    v_and_b32 v93, 0xffff0000, v70
    v_lshlrev_b32 v94, 16, v71
    v_and_b32 v95, 0xffff0000, v71
    v_pk_mul_f32 v[88:89], v[88:89], v[78:79] op_sel:[0,1] op_sel_hi:[1,1]
    v_pk_mul_f32 v[90:91], v[90:91], v[78:79] op_sel:[0,1] op_sel_hi:[1,1]
    v_pk_mul_f32 v[92:93], v[92:93], v[78:79] op_sel:[0,1] op_sel_hi:[1,1]
    v_pk_mul_f32 v[94:95], v[94:95], v[78:79] op_sel:[0,1] op_sel_hi:[1,1]
    v_cvt_pk_bf16_f32 v68, v88, v89
    v_cvt_pk_bf16_f32 v69, v90, v91
    v_cvt_pk_bf16_f32 v70, v92, v93
    v_cvt_pk_bf16_f32 v71, v94, v95
    v_lshlrev_b32 v88, 16, v68
    v_and_b32 v89, 0xffff0000, v68
    v_lshlrev_b32 v90, 16, v69
    v_and_b32 v91, 0xffff0000, v69
    v_lshlrev_b32 v92, 16, v70
    v_and_b32 v93, 0xffff0000, v70
    v_lshlrev_b32 v94, 16, v71
    v_and_b32 v95, 0xffff0000, v71
    v_pk_add_f32 v[48:49], v[48:49], v[88:89]
    v_pk_add_f32 v[50:51], v[50:51], v[90:91]
    v_pk_add_f32 v[52:53], v[52:53], v[92:93]
    v_pk_add_f32 v[54:55], v[54:55], v[94:95]
    v_lshlrev_b32 v56, 16, v72
    v_and_b32 v57, 0xffff0000, v72
    v_lshlrev_b32 v58, 16, v73
    v_and_b32 v59, 0xffff0000, v73
    v_lshlrev_b32 v60, 16, v74
    v_and_b32 v61, 0xffff0000, v74
    v_lshlrev_b32 v62, 16, v75
    v_and_b32 v63, 0xffff0000, v75
    v_pk_add_f32 v[88:89], v[56:57], v[80:81] op_sel_hi:[1,0] neg_lo:[0,1] neg_hi:[0,1]
    v_pk_add_f32 v[90:91], v[58:59], v[80:81] op_sel_hi:[1,0] neg_lo:[0,1] neg_hi:[0,1]
    v_pk_add_f32 v[92:93], v[60:61], v[80:81] op_sel_hi:[1,0] neg_lo:[0,1] neg_hi:[0,1]
    v_pk_add_f32 v[94:95], v[62:63], v[80:81] op_sel_hi:[1,0] neg_lo:[0,1] neg_hi:[0,1]
    v_cvt_pk_bf16_f32 v72, v88, v89
    v_cvt_pk_bf16_f32 v73, v90, v91
    v_cvt_pk_bf16_f32 v74, v92, v93
    v_cvt_pk_bf16_f32 v75, v94, v95
    v_lshlrev_b32 v88, 16, v72
    v_and_b32 v89, 0xffff0000, v72
    v_lshlrev_b32 v90, 16, v73
    v_and_b32 v91, 0xffff0000, v73
    v_lshlrev_b32 v92, 16, v74
    v_and_b32 v93, 0xffff0000, v74
    v_lshlrev_b32 v94, 16, v75
    v_and_b32 v95, 0xffff0000, v75
    v_pk_mul_f32 v[88:89], v[88:89], v[80:81] op_sel:[0,1] op_sel_hi:[1,1]
    v_pk_mul_f32 v[90:91], v[90:91], v[80:81] op_sel:[0,1] op_sel_hi:[1,1]
    v_pk_mul_f32 v[92:93], v[92:93], v[80:81] op_sel:[0,1] op_sel_hi:[1,1]
    v_pk_mul_f32 v[94:95], v[94:95], v[80:81] op_sel:[0,1] op_sel_hi:[1,1]
    v_cvt_pk_bf16_f32 v72, v88, v89
    v_cvt_pk_bf16_f32 v73, v90, v91
    v_cvt_pk_bf16_f32 v74, v92, v93
    v_cvt_pk_bf16_f32 v75, v94, v95
    v_lshlrev_b32 v88, 16, v72
    v_and_b32 v89, 0xffff0000, v72
    v_lshlrev_b32 v90, 16, v73
    v_and_b32 v91, 0xffff0000, v73
    v_lshlrev_b32 v92, 16, v74
    v_and_b32 v93, 0xffff0000, v74
    v_lshlrev_b32 v94, 16, v75
    v_and_b32 v95, 0xffff0000, v75
    v_pk_add_f32 v[56:57], v[56:57], v[88:89]
    v_pk_add_f32 v[58:59], v[58:59], v[90:91]
    v_pk_add_f32 v[60:61], v[60:61], v[92:93]
    v_pk_add_f32 v[62:63], v[62:63], v[94:95]
    s_mul_i32 s16, s20, 20
    s_add_u32 s17, s16, 19
    s_lshr_b32 s16, s16, 7
    s_lshr_b32 s17, s17, 7
    s_sub_u32 s17, s17, s16
    v_bfe_u32 v2, v0, 4, 1
    v_mul_u32_u24 v2, s17, v2
    v_lshrrev_b32 v3, 5, v0
    v_mad_u32_u24 v2, v3, 5, v2
    s_add_u32 s18, s16, 5
    v_add_u32 v2, s18, v2
    v_and_b32 v4, 15, v0
    v_and_b32 v3, 8, v0
    v_lshl_add_u32 v3, v2, 4, v3
    v_lshlrev_b32 v67, 8, v3
    v_lshl_add_u32 v2, v2, 4, v4
    v_lshlrev_b32 v64, 8, v2
    v_bfe_u32 v2, v0, 2, 1
    v_mul_u32_u24 v2, s17, v2
    v_bfe_u32 v3, v0, 3, 1
    v_mad_u32_u24 v2, v3, 5, v2
    v_add_u32 v2, s18, v2
    v_and_b32 v3, 1, v0
    v_lshl_add_u32 v2, v2, 4, v3
    v_bfe_u32 v3, v0, 1, 1
    v_lshl_add_u32 v2, v3, 3, v2
    v_add_u32 v2, 1, v2
    v_lshlrev_b32 v70, 8, v2
    v_lshlrev_b32 v66, 8, v4
    v_add_u32 v66, 10960896, v66
    v_and_b32 v2, 1, v0
    v_mul_u32_u24 v2, s17, v2
    v_add_u32 v2, s16, v2
    v_bfe_u32 v3, v0, 1, 1
    v_lshl_add_u32 v2, v2, 4, v3
    s_lshl_b32 s18, s21, 1
    v_add_u32 v2, s18, v2
    v_lshlrev_b32 v65, 8, v2
    s_cmp_eq_u32 s57, -1
    s_cbranch_scc1 P2_HELP4
    s_barrier
    s_cmp_lg_u32 s3, 4
    s_cbranch_scc1 P2_HELP1
    v_mov_b32 v2, 1
    s_mov_b64 exec, 1
    buffer_store_dword v2, off, s[60:63], s57 offset:0 sc1
    s_mov_b64 exec, -1
P2_HELP4:
    s_cmp_lg_u32 s3, 4
    s_cbranch_scc1 P2_HELP1
    s_mov_b32 s16, 10551296
    s_waitcnt vmcnt(0)
    s_mov_b32 s19, 0
POLL5:
    buffer_load_dword v2, v67, s[60:63], s16 offen sc1
    buffer_load_dword v3, v65, s[60:63], s16 offen sc1
    s_add_u32 s19, s19, 1
    s_cmp_gt_u32 s19, 200000
    s_cbranch_scc1 POLLX5
    s_waitcnt vmcnt(0)
    v_min_u32 v2, v2, v3
    v_cmp_eq_u32 vcc, 0, v2
    s_nop 0
    s_mov_b64 exec, vcc
    s_cbranch_execnz POLL5
POLLX5:
    s_mov_b64 exec, -1
    s_waitcnt vmcnt(0)
P2_HELP1:
    s_barrier
    s_lshl_b32 s52, s55, 10
    s_lshl_b32 s53, s55, 8
    s_add_u32 s53, s53, 73728
    s_lshl_b32 s54, s55, 9
    s_add_u32 s54, s54, s48
P2_STAGE:
    s_add_u32 m0, s52, 0
    s_add_u32 s16, s52, 73728
    buffer_load_dwordx4 v1, s[32:35], m0 offen sc1 lds
    s_add_u32 m0, s52, 81920
    s_nop 0
    buffer_load_dwordx4 v1, s[32:35], s16 offen sc1 lds
    s_add_u32 m0, s53, 0
    s_add_u32 s16, s54, 0
    buffer_load_dword v6, s[60:63], s16 offen sc1 lds
    s_add_u32 m0, s53, 81920
    s_add_u32 s16, s54, 16384
    buffer_load_dword v6, s[60:63], s16 offen sc1 lds
    s_add_u32 m0, s52, 4096
    s_add_u32 s16, s52, 77824
    buffer_load_dwordx4 v1, s[32:35], m0 offen sc1 lds
    s_add_u32 m0, s52, 86016
    s_nop 0
    buffer_load_dwordx4 v1, s[32:35], s16 offen sc1 lds
    s_cmp_lg_u32 s26, 0
    s_cbranch_scc1 P2_STAGE1
    s_mov_b32 s17, 10551296
    v_mov_b32 v71, 1
    s_mov_b64 exec, 0xffff
    buffer_load_dword v71, v70, s[60:63], s17 offen sc1
    s_mov_b64 exec, -1
    s_waitcnt vmcnt(1)
    s_barrier
    s_waitcnt vmcnt(0)
    v_cmp_eq_u32 vcc, 0, v71
    s_nop 0
    s_cbranch_vccz P2_STAGE0
    s_mov_b64 exec, 0xffff
    s_mov_b32 s19, 0
POLL6:
    buffer_load_dword v2, v70, s[60:63], s17 offen sc1
    s_add_u32 s19, s19, 1
    s_cmp_gt_u32 s19, 200000
    s_cbranch_scc1 POLLX6
    s_waitcnt vmcnt(0)
    v_cmp_eq_u32 vcc, 0, v2
    s_nop 0
    s_mov_b64 exec, vcc
    s_cbranch_execnz POLL6
POLLX6:
    s_mov_b64 exec, -1
    s_waitcnt vmcnt(0)
P2_STAGE0:
    s_cmp_lg_u32 s3, 4
    s_cbranch_scc1 P2_STAGE1
    buffer_load_dword v68, v64, s[60:63], s17 offen sc1
    buffer_load_dword v69, v66, s[60:63], 0 offen sc1
P2_STAGE1:
    s_add_u32 m0, s52, 8192
    s_add_u32 s16, s52, 81920
    buffer_load_dwordx4 v1, s[32:35], m0 offen sc1 lds
    s_add_u32 m0, s52, 90112
    s_nop 0
    buffer_load_dwordx4 v1, s[32:35], s16 offen sc1 lds
    s_add_u32 m0, s53, 1024
    s_add_u32 s16, s54, 2048
    buffer_load_dword v6, s[60:63], s16 offen sc1 lds
    s_add_u32 m0, s53, 82944
    s_add_u32 s16, s54, 18432
    buffer_load_dword v6, s[60:63], s16 offen sc1 lds
    s_add_u32 m0, s52, 12288
    s_add_u32 s16, s52, 86016
    buffer_load_dwordx4 v1, s[32:35], m0 offen sc1 lds
    s_add_u32 m0, s52, 94208
    s_nop 0
    buffer_load_dwordx4 v1, s[32:35], s16 offen sc1 lds
    s_add_u32 m0, s52, 16384
    s_add_u32 s16, s52, 90112
    buffer_load_dwordx4 v1, s[32:35], m0 offen sc1 lds
    s_add_u32 m0, s52, 98304
    s_nop 0
    buffer_load_dwordx4 v1, s[32:35], s16 offen sc1 lds
    s_add_u32 m0, s52, 20480
    s_add_u32 s16, s52, 94208
    buffer_load_dwordx4 v1, s[32:35], m0 offen sc1 lds
    s_add_u32 m0, s52, 102400
    s_nop 0
    buffer_load_dwordx4 v1, s[32:35], s16 offen sc1 lds
    s_cmp_lg_u32 s26, 0
    s_cbranch_scc1 P2_STAGE2
    s_waitcnt vmcnt(4)
    s_cmp_lg_u32 s3, 4
    s_cbranch_scc1 P2_STAGE4
    v_min_u32 v68, v68, v69
    v_cmp_eq_u32 vcc, 0, v68
    s_nop 0
    s_cbranch_vccz P2_STAGE4
    s_mov_b32 s19, 0
POLL7:
    buffer_load_dword v2, v64, s[60:63], s17 offen sc1
    buffer_load_dword v4, v66, s[60:63], 0 offen sc1
    s_add_u32 s19, s19, 1
    s_cmp_gt_u32 s19, 200000
    s_cbranch_scc1 POLLX7
    s_waitcnt vmcnt(0)
    v_min_u32 v2, v2, v4
    v_cmp_eq_u32 vcc, 0, v2
    s_nop 0
    s_mov_b64 exec, vcc
    s_cbranch_execnz POLL7
POLLX7:
    s_mov_b64 exec, -1
    s_waitcnt vmcnt(0)
P2_STAGE4:
    s_barrier
P2_STAGE2:
    s_lshl_b32 s58, s55, 12
    s_add_u32 m0, s53, 2048
    s_add_u32 s16, s54, 4096
    buffer_load_dword v6, s[60:63], s16 offen sc1 lds
    s_add_u32 m0, s53, 83968
    s_add_u32 s16, s54, 20480
    buffer_load_dword v6, s[60:63], s16 offen sc1 lds
    s_add_u32 m0, s58, 24576
    s_add_u32 s16, s58, 24576
    buffer_load_dwordx4 v1, s[32:35], s16 offen offset:0 sc1 lds
    buffer_load_dwordx4 v1, s[32:35], s16 offen offset:1024 sc1 lds
    buffer_load_dwordx4 v1, s[32:35], s16 offen offset:2048 sc1 lds
    buffer_load_dwordx4 v1, s[32:35], s16 offen offset:3072 sc1 lds
    s_add_u32 m0, s58, 106496
    s_add_u32 s16, s58, 98304
    buffer_load_dwordx4 v1, s[32:35], s16 offen offset:0 sc1 lds
    buffer_load_dwordx4 v1, s[32:35], s16 offen offset:1024 sc1 lds
    buffer_load_dwordx4 v1, s[32:35], s16 offen offset:2048 sc1 lds
    buffer_load_dwordx4 v1, s[32:35], s16 offen offset:3072 sc1 lds
    s_add_u32 m0, s53, 3072
    s_add_u32 s16, s54, 6144
    buffer_load_dword v6, s[60:63], s16 offen sc1 lds
    s_add_u32 m0, s53, 84992
    s_add_u32 s16, s54, 22528
    buffer_load_dword v6, s[60:63], s16 offen sc1 lds
    s_add_u32 m0, s53, 4096
    s_add_u32 s16, s54, 8192
    buffer_load_dword v6, s[60:63], s16 offen sc1 lds
    s_add_u32 m0, s53, 86016
    s_add_u32 s16, s54, 24576
    buffer_load_dword v6, s[60:63], s16 offen sc1 lds
    s_add_u32 m0, s58, 40960
    s_add_u32 s16, s58, 40960
    buffer_load_dwordx4 v1, s[32:35], s16 offen offset:0 sc1 lds
    buffer_load_dwordx4 v1, s[32:35], s16 offen offset:1024 sc1 lds
    buffer_load_dwordx4 v1, s[32:35], s16 offen offset:2048 sc1 lds
    buffer_load_dwordx4 v1, s[32:35], s16 offen offset:3072 sc1 lds
    s_add_u32 m0, s58, 122880
    s_add_u32 s16, s58, 114688
    buffer_load_dwordx4 v1, s[32:35], s16 offen offset:0 sc1 lds
    buffer_load_dwordx4 v1, s[32:35], s16 offen offset:1024 sc1 lds
    buffer_load_dwordx4 v1, s[32:35], s16 offen offset:2048 sc1 lds
    buffer_load_dwordx4 v1, s[32:35], s16 offen offset:3072 sc1 lds
    s_add_u32 m0, s53, 5120
    s_add_u32 s16, s54, 10240
    buffer_load_dword v6, s[60:63], s16 offen sc1 lds
    s_add_u32 m0, s53, 87040
    s_add_u32 s16, s54, 26624
    buffer_load_dword v6, s[60:63], s16 offen sc1 lds
    s_add_u32 m0, s53, 6144
    s_add_u32 s16, s54, 12288
    buffer_load_dword v6, s[60:63], s16 offen sc1 lds
    s_add_u32 m0, s53, 88064
    s_add_u32 s16, s54, 28672
    buffer_load_dword v6, s[60:63], s16 offen sc1 lds
    s_add_u32 m0, s58, 57344
    s_add_u32 s16, s58, 57344
    buffer_load_dwordx4 v1, s[32:35], s16 offen offset:0 sc1 lds
    buffer_load_dwordx4 v1, s[32:35], s16 offen offset:1024 sc1 lds
    buffer_load_dwordx4 v1, s[32:35], s16 offen offset:2048 sc1 lds
    buffer_load_dwordx4 v1, s[32:35], s16 offen offset:3072 sc1 lds
    s_add_u32 m0, s58, 139264
    s_add_u32 s16, s58, 131072
    buffer_load_dwordx4 v1, s[32:35], s16 offen offset:0 sc1 lds
    buffer_load_dwordx4 v1, s[32:35], s16 offen offset:1024 sc1 lds
    buffer_load_dwordx4 v1, s[32:35], s16 offen offset:2048 sc1 lds
    buffer_load_dwordx4 v1, s[32:35], s16 offen offset:3072 sc1 lds
    s_add_u32 m0, s53, 7168
    s_add_u32 s16, s54, 14336
    buffer_load_dword v6, s[60:63], s16 offen sc1 lds
    s_add_u32 m0, s53, 89088
    s_add_u32 s16, s54, 30720
    buffer_load_dword v6, s[60:63], s16 offen sc1 lds
    s_mov_b32 s16, 10502144
    buffer_load_dword v5, v31, s[60:63], s16 offen sc1
    s_waitcnt vmcnt(0)
    s_barrier
    s_cmp_eq_u32 s26, 0
    s_cbranch_scc1 P2_STAGE3
    s_barrier
    s_barrier
    s_barrier
P2_STAGE3:
    s_lshr_b32 s16, s2, 3
    s_lshl_b32 s16, s16, 2
    s_add_u32 s16, s16, s55
    s_mul_i32 s17, s16, 15360
    s_and_b32 s18, s2, 7
    s_mul_i32 s18, s18, 384
    s_add_u32 s17, s17, s18
    s_mov_b64 exec, 0x7fff
    s_mov_b32 s36, s74
    s_mov_b32 s37, s75
    s_mov_b32 s38, 1966080
    s_mov_b32 s39, 0x00020000
    buffer_load_dword v216, v36, s[36:39], s17 offen
    s_mov_b32 s36, s76
    s_mov_b32 s37, s77
    s_mov_b32 s38, 1966080
    s_mov_b32 s39, 0x00020000
    buffer_load_dword v217, v36, s[36:39], s17 offen
    s_mov_b64 exec, -1
    s_cmp_lg_u32 s26, 0
    s_cbranch_scc1 P2_NOFFN
    s_cmp_lg_u32 s27, -1
    s_cbranch_scc1 P2_FFN
    s_cmp_ge_u32 s55, 2
    s_cbranch_scc1 P2_NOFFN
    s_sub_u32 s16, s2, 192
    s_lshr_b32 s12, s16, 2
    s_and_b32 s13, s16, 3
    s_lshl_b32 s13, s13, 1
    s_add_u32 s13, s13, s55
    s_mov_b32 s36, s68
    s_mov_b32 s37, s69
    s_mov_b32 s38, 819200
    s_mov_b32 s39, 0x00020000
    s_mul_i32 s16, s12, 51200
    s_mul_i32 s17, s13, 160
    s_add_u32 s16, s16, s17
    s_add_u32 s17, s16, 40960
    s_mul_i32 s18, s55, 81920
    s_add_u32 m0, s18, 0
    s_nop 0
    buffer_load_dwordx4 v7, s[36:39], s16 offen lds
    s_add_u32 m0, s18, 1024
    s_nop 0
    buffer_load_dwordx4 v8, s[36:39], s16 offen lds
    s_add_u32 m0, s18, 2048
    s_nop 0
    buffer_load_dwordx4 v9, s[36:39], s16 offen lds
    s_add_u32 m0, s18, 3072
    s_nop 0
    buffer_load_dwordx4 v10, s[36:39], s16 offen lds
    s_add_u32 m0, s18, 4096
    s_nop 0
    buffer_load_dwordx4 v11, s[36:39], s16 offen lds
    s_add_u32 m0, s18, 5120
    s_nop 0
    buffer_load_dwordx4 v7, s[36:39], s17 offen lds
    s_add_u32 m0, s18, 6144
    s_mov_b64 exec, 0xffff
    buffer_load_dwordx4 v8, s[36:39], s17 offen lds
    s_mov_b64 exec, -1
    v_lshrrev_b32 v2, 4, v0
    v_bfe_u32 v3, v0, 2, 2
    v_and_b32 v4, 3, v0
    v_lshl_add_u32 v4, v4, 3, s18
    v_lshrrev_b32 v94, 1, v2
    v_mad_u32_u24 v94, v94, 20, v3
    v_and_b32 v95, 1, v2
    v_lshl_add_u32 v94, v95, 2, v94
    v_mul_u32_u24 v94, 160, v94
    v_add_u32 v94, v94, v4
    v_mul_u32_u24 v3, 160, v3
    v_add_u32 v3, v3, v4
    v_lshl_add_u32 v95, v2, 5, v3
    s_mul_i32 s14, s13, 102400
    s_lshr_b32 s15, s12, 3
    s_mul_i32 s15, s15, 51200
    s_add_u32 s14, s14, s15
    s_add_u32 s14, s14, 11010048
    s_and_b32 s15, s12, 7
    s_mul_i32 s15, s15, 5120
    s_add_u32 s15, s15, s14
    s_add_u32 s17, s15, 4096
    s_bfe_u32 s16, s12, 0x10002
    s_add_u32 s16, s16, 8
    s_mul_i32 s16, s16, 5120
    s_add_u32 s14, s14, s16
    s_and_b32 s16, s12, 3
    s_lshl_b32 s16, s16, 8
    s_add_u32 s14, s14, s16
    s_add_u32 s16, s14, 4096
    s_waitcnt vmcnt(0)
    ds_read_b64_tr_b16 v[64:65], v94 offset:0
    ds_read_b64_tr_b16 v[66:67], v94 offset:1280
    ds_read_b64_tr_b16 v[68:69], v94 offset:32
    ds_read_b64_tr_b16 v[70:71], v94 offset:1312
    ds_read_b64_tr_b16 v[72:73], v94 offset:64
    ds_read_b64_tr_b16 v[74:75], v94 offset:1344
    ds_read_b64_tr_b16 v[76:77], v94 offset:96
    ds_read_b64_tr_b16 v[78:79], v94 offset:1376
    ds_read_b64_tr_b16 v[80:81], v94 offset:128
    ds_read_b64_tr_b16 v[82:83], v94 offset:1408
    ds_read_b64_tr_b16 v[84:85], v95 offset:2560
    ds_read_b64_tr_b16 v[88:89], v3 offset:2688
    ds_read_b64_tr_b16 v[86:87], v95 offset:5760
    ds_read_b64_tr_b16 v[90:91], v3 offset:5888
    v_and_b32 v4, 15, v0
    v_lshlrev_b32 v4, 4, v4
    v_lshl_add_u32 v2, v2, 10, v4
    s_waitcnt lgkmcnt(0)
    buffer_store_dwordx4 v[64:67], v1, s[60:63], s15 offen offset:0 sc1
    buffer_store_dwordx4 v[68:71], v1, s[60:63], s15 offen offset:1024 sc1
    buffer_store_dwordx4 v[72:75], v1, s[60:63], s15 offen offset:2048 sc1
    buffer_store_dwordx4 v[76:79], v1, s[60:63], s15 offen offset:3072 sc1
    buffer_store_dwordx4 v[80:83], v1, s[60:63], s17 offen sc1
    buffer_store_dwordx4 v[84:87], v2, s[60:63], s14 offen sc1
    s_mov_b64 exec, 0xffff
    buffer_store_dwordx4 v[88:91], v4, s[60:63], s16 offen sc1
    s_mov_b64 exec, -1
    s_lshl_b32 s13, s13, 4
    s_add_u32 s13, s13, s12
    s_lshl_b32 s13, s13, 8
    s_add_u32 s13, s13, 10928128
    s_waitcnt vmcnt(0)
    v_mov_b32 v2, 1
    s_mov_b64 exec, 1
    buffer_store_dword v2, off, s[60:63], s13 offset:0 sc1
    s_mov_b64 exec, -1
P2_NOFFN:
    v_max_u32_dpp v2, v5, v5 quad_perm:[1,0,3,2] row_mask:0xf bank_mask:0xf
    s_nop 1
    v_max_u32_dpp v2, v2, v2 quad_perm:[2,3,0,1] row_mask:0xf bank_mask:0xf
    s_nop 1
    v_max_u32_dpp v2, v2, v2 row_half_mirror row_mask:0xf bank_mask:0xf
    s_nop 1
    v_max_u32_dpp v2, v2, v2 row_mirror row_mask:0xf bank_mask:0xf
    s_nop 0
    v_readlane_b32 s12, v2, 0
    v_readlane_b32 s13, v2, 16
    v_readlane_b32 s14, v2, 32
    v_readlane_b32 s15, v2, 48
    s_max_u32 s12, s12, s13
    s_max_u32 s14, s14, s15
    s_max_u32 s40, s12, s14
    v_cmp_ne_u32 vcc, s40, v5
    s_nop 1
    v_cndmask_b32 v5, 0, v5, vcc
    s_nop 1
    v_max_u32_dpp v2, v5, v5 quad_perm:[1,0,3,2] row_mask:0xf bank_mask:0xf
    s_nop 1
    v_max_u32_dpp v2, v2, v2 quad_perm:[2,3,0,1] row_mask:0xf bank_mask:0xf
    s_nop 1
    v_max_u32_dpp v2, v2, v2 row_half_mirror row_mask:0xf bank_mask:0xf
    s_nop 1
    v_max_u32_dpp v2, v2, v2 row_mirror row_mask:0xf bank_mask:0xf
    s_nop 0
    v_readlane_b32 s12, v2, 0
    v_readlane_b32 s13, v2, 16
    v_readlane_b32 s14, v2, 32
    v_readlane_b32 s15, v2, 48
    s_max_u32 s12, s12, s13
    s_max_u32 s14, s14, s15
    s_max_u32 s41, s12, s14
    s_cmp_lg_u32 s3, 7
    s_cbranch_scc1 P2_NOFW
    v_and_b32 v2, 15, v0
    v_lshlrev_b32 v2, 8, v2
    s_lshl_b32 s16, s29, 12
    s_add_u32 s16, s16, 10928128
    s_mov_b32 s19, 0
POLL8:
    buffer_load_dword v3, v2, s[60:63], s16 offen sc1
    s_add_u32 s19, s19, 1
    s_cmp_gt_u32 s19, 200000
    s_cbranch_scc1 POLLX8
    s_waitcnt vmcnt(0)
    v_cmp_eq_u32 vcc, 0, v3
    s_nop 0
    s_mov_b64 exec, vcc
    s_cbranch_execnz POLL8
POLLX8:
    s_mov_b64 exec, -1
    s_waitcnt vmcnt(0)
P2_NOFW:
    s_barrier
    s_branch P3_PRE
P2_FFN:
    s_cmp_lg_u32 s3, 4
    s_cbranch_scc1 P2_NOFFN
P2_FFN1:
    v_mul_u32_u24 v64, 3072, v0
    s_lshl_b32 s18, s27, 4
    s_mov_b32 s36, s74
    s_mov_b32 s37, s75
    s_mov_b32 s38, 1966080
    s_mov_b32 s39, 0x00020000
    s_mov_b32 s16, s18
    s_mov_b32 m0, 0
    s_nop 0
    buffer_load_dwordx4 v64, s[36:39], s16 offen lds
    s_add_u32 m0, m0, 1024
    s_add_u32 s16, s16, 196608
    buffer_load_dwordx4 v64, s[36:39], s16 offen lds
    s_add_u32 m0, m0, 1024
    s_add_u32 s16, s16, 196608
    buffer_load_dwordx4 v64, s[36:39], s16 offen lds
    s_add_u32 m0, m0, 1024
    s_add_u32 s16, s16, 196608
    buffer_load_dwordx4 v64, s[36:39], s16 offen lds
    s_add_u32 m0, m0, 1024
    s_add_u32 s16, s16, 196608
    buffer_load_dwordx4 v64, s[36:39], s16 offen lds
    s_add_u32 m0, m0, 1024
    s_add_u32 s16, s16, 196608
    buffer_load_dwordx4 v64, s[36:39], s16 offen lds
    s_add_u32 m0, m0, 1024
    s_add_u32 s16, s16, 196608
    buffer_load_dwordx4 v64, s[36:39], s16 offen lds
    s_add_u32 m0, m0, 1024
    s_add_u32 s16, s16, 196608
    buffer_load_dwordx4 v64, s[36:39], s16 offen lds
    s_add_u32 m0, m0, 1024
    s_add_u32 s16, s16, 196608
    buffer_load_dwordx4 v64, s[36:39], s16 offen lds
    s_add_u32 m0, m0, 1024
    s_add_u32 s16, s16, 196608
    buffer_load_dwordx4 v64, s[36:39], s16 offen lds
    s_mov_b32 s36, s76
    s_mov_b32 s37, s77
    s_mov_b32 s38, 1966080
    s_mov_b32 s39, 0x00020000
    s_mov_b32 s16, s18
    s_mov_b32 m0, 81920
    s_nop 0
    buffer_load_dwordx4 v64, s[36:39], s16 offen lds
    s_add_u32 m0, m0, 1024
    s_add_u32 s16, s16, 196608
    buffer_load_dwordx4 v64, s[36:39], s16 offen lds
    s_add_u32 m0, m0, 1024
    s_add_u32 s16, s16, 196608
    buffer_load_dwordx4 v64, s[36:39], s16 offen lds
    s_add_u32 m0, m0, 1024
    s_add_u32 s16, s16, 196608
    buffer_load_dwordx4 v64, s[36:39], s16 offen lds
    s_add_u32 m0, m0, 1024
    s_add_u32 s16, s16, 196608
    buffer_load_dwordx4 v64, s[36:39], s16 offen lds
    s_add_u32 m0, m0, 1024
    s_add_u32 s16, s16, 196608
    buffer_load_dwordx4 v64, s[36:39], s16 offen lds
    s_add_u32 m0, m0, 1024
    s_add_u32 s16, s16, 196608
    buffer_load_dwordx4 v64, s[36:39], s16 offen lds
    s_add_u32 m0, m0, 1024
    s_add_u32 s16, s16, 196608
    buffer_load_dwordx4 v64, s[36:39], s16 offen lds
    s_add_u32 m0, m0, 1024
    s_add_u32 s16, s16, 196608
    buffer_load_dwordx4 v64, s[36:39], s16 offen lds
    s_add_u32 m0, m0, 1024
    s_add_u32 s16, s16, 196608
    buffer_load_dwordx4 v64, s[36:39], s16 offen lds
    v_max_u32_dpp v2, v5, v5 quad_perm:[1,0,3,2] row_mask:0xf bank_mask:0xf
    s_nop 1
    v_max_u32_dpp v2, v2, v2 quad_perm:[2,3,0,1] row_mask:0xf bank_mask:0xf
    s_nop 1
    v_max_u32_dpp v2, v2, v2 row_half_mirror row_mask:0xf bank_mask:0xf
    s_nop 1
    v_max_u32_dpp v2, v2, v2 row_mirror row_mask:0xf bank_mask:0xf
    s_nop 0
    v_readlane_b32 s12, v2, 0
    v_readlane_b32 s13, v2, 16
    v_readlane_b32 s14, v2, 32
    v_readlane_b32 s15, v2, 48
    s_max_u32 s12, s12, s13
    s_max_u32 s14, s14, s15
    s_max_u32 s40, s12, s14
    v_cmp_ne_u32 vcc, s40, v5
    s_nop 1
    v_cndmask_b32 v5, 0, v5, vcc
    s_nop 1
    v_max_u32_dpp v2, v5, v5 quad_perm:[1,0,3,2] row_mask:0xf bank_mask:0xf
    s_nop 1
    v_max_u32_dpp v2, v2, v2 quad_perm:[2,3,0,1] row_mask:0xf bank_mask:0xf
    s_nop 1
    v_max_u32_dpp v2, v2, v2 row_half_mirror row_mask:0xf bank_mask:0xf
    s_nop 1
    v_max_u32_dpp v2, v2, v2 row_mirror row_mask:0xf bank_mask:0xf
    s_nop 0
    v_readlane_b32 s12, v2, 0
    v_readlane_b32 s13, v2, 16
    v_readlane_b32 s14, v2, 32
    v_readlane_b32 s15, v2, 48
    s_max_u32 s12, s12, s13
    s_max_u32 s14, s14, s15
    s_max_u32 s41, s12, s14
    s_andn2_b32 s42, 2047, s40
    s_andn2_b32 s43, 2047, s41
    s_mov_b32 m0, 10240
    s_mul_i32 s16, s42, 1280
    buffer_load_dwordx4 v1, s[4:7], s16 offen lds
    s_mov_b64 exec, 0xffff
    buffer_load_dwordx4 v1, s[4:7], s16 offen offset:1024 lds
    s_mov_b64 exec, -1
    s_mov_b32 m0, 11520
    s_mul_i32 s16, s43, 1280
    buffer_load_dwordx4 v1, s[4:7], s16 offen lds
    s_mov_b64 exec, 0xffff
    buffer_load_dwordx4 v1, s[4:7], s16 offen offset:1024 lds
    s_mov_b64 exec, -1
    s_lshl_b32 s16, s42, 3
    s_add_u32 s16, s16, 10485760
    buffer_load_dwordx2 v[164:165], off, s[60:63], s16 sc1
    s_lshl_b32 s16, s43, 3
    s_add_u32 s16, s16, 10485760
    buffer_load_dwordx2 v[166:167], off, s[60:63], s16 sc1
    s_mov_b32 s36, s78
    s_mov_b32 s37, s79
    s_mov_b32 s38, 1966080
    s_mov_b32 s39, 0x00020000
    s_mul_i32 s16, s27, 10240
    buffer_load_dwordx4 v[176:179], v1, s[36:39], s16 offen offset:0
    buffer_load_dwordx4 v[180:183], v1, s[36:39], s16 offen offset:1024
    buffer_load_dwordx4 v[184:187], v1, s[36:39], s16 offen offset:2048
    buffer_load_dwordx4 v[188:191], v1, s[36:39], s16 offen offset:3072
    s_add_u32 s16, s16, 4096
    buffer_load_dwordx4 v[192:195], v1, s[36:39], s16 offen offset:0
    buffer_load_dwordx4 v[196:199], v1, s[36:39], s16 offen offset:1024
    buffer_load_dwordx4 v[200:203], v1, s[36:39], s16 offen offset:2048
    buffer_load_dwordx4 v[204:207], v1, s[36:39], s16 offen offset:3072
    s_add_u32 s16, s16, 4096
    buffer_load_dwordx4 v[208:211], v1, s[36:39], s16 offen offset:0
    buffer_load_dwordx4 v[212:215], v1, s[36:39], s16 offen offset:1024
    v_mov_b32 v68, 1065369472
    v_mov_b32 v69, 1065369472
    v_mov_b32 v70, 1065369472
    v_mov_b32 v71, 1065369472
    v_mov_b32 v72, 0
    v_mov_b32 v73, 0
    v_mov_b32 v74, 0
    v_mov_b32 v75, 0
    v_add_u32 v5, 92160, v1
    ds_write_b128 v5, v[68:71]
    ds_write_b128 v5, v[68:71] offset:256
    ds_write_b128 v5, v[72:75] offset:1280
    s_waitcnt vmcnt(0) lgkmcnt(0)
    ds_read_b128 v[72:75], v32 offset:10240
    ds_read_b64_tr_b16 v[88:89], v33 offset:0
    ds_read_b64_tr_b16 v[90:91], v33 offset:64
    ds_read_b128 v[76:79], v32 offset:10304
    ds_read_b64_tr_b16 v[92:93], v33 offset:512
    ds_read_b64_tr_b16 v[94:95], v33 offset:576
    ds_read_b128 v[80:83], v32 offset:10368
    ds_read_b64_tr_b16 v[96:97], v33 offset:1024
    ds_read_b64_tr_b16 v[98:99], v33 offset:1088
    ds_read_b128 v[84:87], v32 offset:10432
    ds_read_b64_tr_b16 v[100:101], v33 offset:1536
    ds_read_b64_tr_b16 v[102:103], v33 offset:1600
    s_waitcnt lgkmcnt(9)
    v_mfma_f32_16x16x32_bf16 v[68:71], v[72:75], v[88:91], 0
    ds_read_b128 v[72:75], v32 offset:10496
    ds_read_b64_tr_b16 v[88:89], v33 offset:2048
    ds_read_b64_tr_b16 v[90:91], v33 offset:2112
    s_waitcnt lgkmcnt(9)
    v_mfma_f32_16x16x32_bf16 v[68:71], v[76:79], v[92:95], v[68:71]
    ds_read_b128 v[76:79], v32 offset:10560
    ds_read_b64_tr_b16 v[92:93], v33 offset:2560
    ds_read_b64_tr_b16 v[94:95], v33 offset:2624
    s_waitcnt lgkmcnt(9)
    v_mfma_f32_16x16x32_bf16 v[68:71], v[80:83], v[96:99], v[68:71]
    ds_read_b128 v[80:83], v32 offset:10624
    ds_read_b64_tr_b16 v[96:97], v33 offset:3072
    ds_read_b64_tr_b16 v[98:99], v33 offset:3136
    s_waitcnt lgkmcnt(9)
    v_mfma_f32_16x16x32_bf16 v[68:71], v[84:87], v[100:103], v[68:71]
    ds_read_b128 v[84:87], v32 offset:10688
    ds_read_b64_tr_b16 v[100:101], v33 offset:3584
    ds_read_b64_tr_b16 v[102:103], v33 offset:3648
    s_waitcnt lgkmcnt(9)
    v_mfma_f32_16x16x32_bf16 v[68:71], v[72:75], v[88:91], v[68:71]
    ds_read_b128 v[72:75], v32 offset:10752
    ds_read_b64_tr_b16 v[88:89], v33 offset:4096
    ds_read_b64_tr_b16 v[90:91], v33 offset:4160
    s_waitcnt lgkmcnt(9)
    v_mfma_f32_16x16x32_bf16 v[68:71], v[76:79], v[92:95], v[68:71]
    ds_read_b128 v[76:79], v32 offset:10816
    ds_read_b64_tr_b16 v[92:93], v33 offset:4608
    ds_read_b64_tr_b16 v[94:95], v33 offset:4672
    s_waitcnt lgkmcnt(9)
    v_mfma_f32_16x16x32_bf16 v[68:71], v[80:83], v[96:99], v[68:71]
    ds_read_b128 v[80:83], v32 offset:10880
    ds_read_b64_tr_b16 v[96:97], v33 offset:5120
    ds_read_b64_tr_b16 v[98:99], v33 offset:5184
    s_waitcnt lgkmcnt(9)
    v_mfma_f32_16x16x32_bf16 v[68:71], v[84:87], v[100:103], v[68:71]
    ds_read_b128 v[84:87], v32 offset:10944
    ds_read_b64_tr_b16 v[100:101], v33 offset:5632
    ds_read_b64_tr_b16 v[102:103], v33 offset:5696
    s_waitcnt lgkmcnt(9)
    v_mfma_f32_16x16x32_bf16 v[68:71], v[72:75], v[88:91], v[68:71]
    ds_read_b128 v[72:75], v32 offset:11008
    ds_read_b64_tr_b16 v[88:89], v33 offset:6144
    ds_read_b64_tr_b16 v[90:91], v33 offset:6208
    s_waitcnt lgkmcnt(9)
    v_mfma_f32_16x16x32_bf16 v[68:71], v[76:79], v[92:95], v[68:71]
    ds_read_b128 v[76:79], v32 offset:11072
    ds_read_b64_tr_b16 v[92:93], v33 offset:6656
    ds_read_b64_tr_b16 v[94:95], v33 offset:6720
    s_waitcnt lgkmcnt(9)
    v_mfma_f32_16x16x32_bf16 v[68:71], v[80:83], v[96:99], v[68:71]
    ds_read_b128 v[80:83], v32 offset:11136
    ds_read_b64_tr_b16 v[96:97], v33 offset:7168
    ds_read_b64_tr_b16 v[98:99], v33 offset:7232
    s_waitcnt lgkmcnt(9)
    v_mfma_f32_16x16x32_bf16 v[68:71], v[84:87], v[100:103], v[68:71]
    ds_read_b128 v[84:87], v32 offset:11200
    ds_read_b64_tr_b16 v[100:101], v33 offset:7680
    ds_read_b64_tr_b16 v[102:103], v33 offset:7744
    s_waitcnt lgkmcnt(9)
    v_mfma_f32_16x16x32_bf16 v[68:71], v[72:75], v[88:91], v[68:71]
    ds_read_b128 v[72:75], v32 offset:11264
    ds_read_b64_tr_b16 v[88:89], v33 offset:8192
    ds_read_b64_tr_b16 v[90:91], v33 offset:8256
    s_waitcnt lgkmcnt(9)
    v_mfma_f32_16x16x32_bf16 v[68:71], v[76:79], v[92:95], v[68:71]
    ds_read_b128 v[76:79], v32 offset:11328
    ds_read_b64_tr_b16 v[92:93], v33 offset:8704
    ds_read_b64_tr_b16 v[94:95], v33 offset:8768
    s_waitcnt lgkmcnt(9)
    v_mfma_f32_16x16x32_bf16 v[68:71], v[80:83], v[96:99], v[68:71]
    ds_read_b128 v[80:83], v32 offset:11392
    ds_read_b64_tr_b16 v[96:97], v33 offset:9216
    ds_read_b64_tr_b16 v[98:99], v33 offset:9280
    s_waitcnt lgkmcnt(9)
    v_mfma_f32_16x16x32_bf16 v[68:71], v[84:87], v[100:103], v[68:71]
    ds_read_b128 v[84:87], v32 offset:11456
    ds_read_b64_tr_b16 v[100:101], v33 offset:9728
    ds_read_b64_tr_b16 v[102:103], v33 offset:9792
    s_waitcnt lgkmcnt(9)
    v_mfma_f32_16x16x32_bf16 v[68:71], v[72:75], v[88:91], v[68:71]
    s_waitcnt lgkmcnt(6)
    v_mfma_f32_16x16x32_bf16 v[68:71], v[76:79], v[92:95], v[68:71]
    s_waitcnt lgkmcnt(3)
    v_mfma_f32_16x16x32_bf16 v[68:71], v[80:83], v[96:99], v[68:71]
    s_waitcnt lgkmcnt(0)
    v_mfma_f32_16x16x32_bf16 v[68:71], v[84:87], v[100:103], v[68:71]
    s_setprio 2
    ds_write_b128 v1, v[176:179] offset:0
    ds_write_b128 v1, v[180:183] offset:1024
    ds_write_b128 v1, v[184:187] offset:2048
    ds_write_b128 v1, v[188:191] offset:3072
    ds_write_b128 v1, v[192:195] offset:4096
    ds_write_b128 v1, v[196:199] offset:5120
    ds_write_b128 v1, v[200:203] offset:6144
    ds_write_b128 v1, v[204:207] offset:7168
    ds_write_b128 v1, v[208:211] offset:8192
    ds_write_b128 v1, v[212:215] offset:9216
    v_fma_f32 v72, -v164, v70, v68
    v_mul_f32 v72, v165, v72
    v_fma_f32 v73, -v166, v70, v69
    v_mul_f32 v73, v167, v73
    v_cvt_pk_bf16_f32 v2, v72, v73
    v_lshlrev_b32 v72, 16, v2
    v_and_b32 v73, 0xffff0000, v2
    s_nop 0
    v_mov_b32_dpp v74, v72 row_shl:8 row_mask:0xf bank_mask:0xf bound_ctrl:1
    v_mul_f32 v76, 0xbfb8aa3b, v72
    v_mov_b32_dpp v75, v73 row_shl:8 row_mask:0xf bank_mask:0xf bound_ctrl:1
    v_mul_f32 v77, 0xbfb8aa3b, v73
    v_exp_f32 v76, v76
    v_exp_f32 v77, v77
    v_add_f32 v76, 1.0, v76
    v_add_f32 v77, 1.0, v77
    v_rcp_f32 v76, v76
    v_rcp_f32 v77, v77
    v_mul_f32 v72, v72, v76
    v_mul_f32 v73, v73, v77
    v_cvt_pk_bf16_f32 v2, v72, v73
    v_lshlrev_b32 v72, 16, v2
    v_and_b32 v73, 0xffff0000, v2
    v_mul_f32 v72, v72, v74
    v_mul_f32 v73, v73, v75
    v_cvt_pk_bf16_f32 v2, v72, v73
    v_lshlrev_b32 v3, 1, v0
    v_add_u32 v3, 93440, v3
    s_mov_b64 exec, 0xff
    ds_write_b16 v3, v2
    ds_write_b16_d16_hi v3, v2 offset:16
    s_mov_b64 exec, -1
    s_waitcnt lgkmcnt(0)
    ds_read_b128 v[68:71], v34
    s_and_b32 s16, s2, 7
    s_mul_i32 s16, s16, 5120
    s_add_u32 s16, s16, 10506240
    s_add_u32 s17, s16, 2560
    v_lshlrev_b32 v3, 2, v0
    s_setprio 0
    ds_read_b64_tr_b16 v[72:73], v35 offset:0
    ds_read_b64_tr_b16 v[74:75], v35 offset:5120
    ds_read_b64_tr_b16 v[76:77], v35 offset:128
    ds_read_b64_tr_b16 v[78:79], v35 offset:5248
    ds_read_b64_tr_b16 v[80:81], v35 offset:256
    ds_read_b64_tr_b16 v[82:83], v35 offset:5376
    ds_read_b64_tr_b16 v[84:85], v35 offset:384
    ds_read_b64_tr_b16 v[86:87], v35 offset:5504
    ds_read_b64_tr_b16 v[88:89], v35 offset:512
    ds_read_b64_tr_b16 v[90:91], v35 offset:5632
    s_waitcnt lgkmcnt(8)
    v_mfma_f32_16x16x32_bf16 v[112:115], v[68:71], v[72:75], 0
    s_waitcnt lgkmcnt(6)
    v_mfma_f32_16x16x32_bf16 v[116:119], v[68:71], v[76:79], 0
    s_waitcnt lgkmcnt(4)
    v_mfma_f32_16x16x32_bf16 v[120:123], v[68:71], v[80:83], 0
    s_waitcnt lgkmcnt(2)
    v_mfma_f32_16x16x32_bf16 v[124:127], v[68:71], v[84:87], 0
    s_waitcnt lgkmcnt(0)
    v_mfma_f32_16x16x32_bf16 v[128:131], v[68:71], v[88:91], 0
    ds_read_b64_tr_b16 v[92:93], v35 offset:640
    ds_read_b64_tr_b16 v[94:95], v35 offset:5760
    ds_read_b64_tr_b16 v[96:97], v35 offset:768
    ds_read_b64_tr_b16 v[98:99], v35 offset:5888
    ds_read_b64_tr_b16 v[100:101], v35 offset:896
    ds_read_b64_tr_b16 v[102:103], v35 offset:6016
    ds_read_b64_tr_b16 v[104:105], v35 offset:1024
    ds_read_b64_tr_b16 v[106:107], v35 offset:6144
    ds_read_b64_tr_b16 v[108:109], v35 offset:1152
    ds_read_b64_tr_b16 v[110:111], v35 offset:6272
    s_waitcnt lgkmcnt(8)
    v_mfma_f32_16x16x32_bf16 v[132:135], v[68:71], v[92:95], 0
    s_waitcnt lgkmcnt(6)
    v_mfma_f32_16x16x32_bf16 v[136:139], v[68:71], v[96:99], 0
    s_waitcnt lgkmcnt(4)
    v_mfma_f32_16x16x32_bf16 v[140:143], v[68:71], v[100:103], 0
    s_waitcnt lgkmcnt(2)
    v_mfma_f32_16x16x32_bf16 v[144:147], v[68:71], v[104:107], 0
    s_waitcnt lgkmcnt(0)
    v_mfma_f32_16x16x32_bf16 v[148:151], v[68:71], v[108:111], 0
    buffer_atomic_add_f32 v112, v3, s[60:63], s16 offen offset:0
    buffer_atomic_add_f32 v113, v3, s[60:63], s17 offen offset:0
    buffer_atomic_add_f32 v116, v3, s[60:63], s16 offen offset:256
    buffer_atomic_add_f32 v117, v3, s[60:63], s17 offen offset:256
    buffer_atomic_add_f32 v120, v3, s[60:63], s16 offen offset:512
    buffer_atomic_add_f32 v121, v3, s[60:63], s17 offen offset:512
    buffer_atomic_add_f32 v124, v3, s[60:63], s16 offen offset:768
    buffer_atomic_add_f32 v125, v3, s[60:63], s17 offen offset:768
    buffer_atomic_add_f32 v128, v3, s[60:63], s16 offen offset:1024
    buffer_atomic_add_f32 v129, v3, s[60:63], s17 offen offset:1024
    buffer_atomic_add_f32 v132, v3, s[60:63], s16 offen offset:1280
    buffer_atomic_add_f32 v133, v3, s[60:63], s17 offen offset:1280
    buffer_atomic_add_f32 v136, v3, s[60:63], s16 offen offset:1536
    buffer_atomic_add_f32 v137, v3, s[60:63], s17 offen offset:1536
    buffer_atomic_add_f32 v140, v3, s[60:63], s16 offen offset:1792
    buffer_atomic_add_f32 v141, v3, s[60:63], s17 offen offset:1792
    buffer_atomic_add_f32 v144, v3, s[60:63], s16 offen offset:2048
    buffer_atomic_add_f32 v145, v3, s[60:63], s17 offen offset:2048
    buffer_atomic_add_f32 v148, v3, s[60:63], s16 offen offset:2304
    buffer_atomic_add_f32 v149, v3, s[60:63], s17 offen offset:2304
    s_setprio 0
    s_lshl_b32 s16, s27, 8
    s_add_u32 s16, s16, 10878976
    s_waitcnt vmcnt(0)
    v_mov_b32 v2, 1
    s_mov_b64 exec, 1
    buffer_store_dword v2, off, s[60:63], s16 offset:0 sc1
    s_mov_b64 exec, -1
    s_barrier
P3_PRE:
    s_mov_b32 s8, s80
    s_mov_b32 s9, s81
    s_mov_b32 s10, 2621440
    s_mov_b32 s11, 0x00020000
    s_mov_b32 s23, 0
    s_andn2_b32 s42, 0xffff, s40
    s_lshr_b32 s16, s42, 4
    s_cmp_eq_u32 s16, s22
    s_cselect_b32 s16, 1, 0
    s_or_b32 s23, s23, s16
    s_andn2_b32 s43, 0xffff, s41
    s_lshr_b32 s16, s43, 4
    s_cmp_eq_u32 s16, s22
    s_cselect_b32 s16, 2, 0
    s_or_b32 s23, s23, s16
    s_cmp_lg_u32 s26, 0
    s_cselect_b32 s23, 0, s23
    s_cmp_eq_u32 s23, 0
    s_cbranch_scc1 P3_NOY0
    s_setprio 2
    v_lshlrev_b32 v2, 8, v0
    s_mov_b32 s16, 10878976
    s_mov_b32 s17, 10895360
    s_mov_b32 s18, 10911744
    s_mov_b32 s19, 0
POLL9:
    buffer_load_dword v3, v2, s[60:63], s16 offen sc1
    buffer_load_dword v4, v2, s[60:63], s17 offen sc1
    buffer_load_dword v5, v2, s[60:63], s18 offen sc1
    s_add_u32 s19, s19, 1
    s_cmp_gt_u32 s19, 200000
    s_cbranch_scc1 POLLX9
    s_waitcnt vmcnt(0)
    v_min_u32 v3, v3, v4
    v_min_u32 v3, v3, v5
    v_cmp_eq_u32 vcc, 0, v3
    s_nop 0
    s_mov_b64 exec, vcc
    s_cbranch_execnz POLL9
POLLX9:
    s_mov_b64 exec, -1
    s_waitcnt vmcnt(0)
    s_mul_i32 s16, s29, 320
    s_add_u32 s16, s16, 10506240
    s_mov_b64 exec, 0xfffff
    buffer_load_dwordx4 v[64:67], v1, s[60:63], s16 offen offset:0 sc1
    buffer_load_dwordx4 v[96:99], v1, s[60:63], s16 offen offset:2560 sc1
    s_add_u32 s16, s16, 5120
    buffer_load_dwordx4 v[68:71], v1, s[60:63], s16 offen offset:0 sc1
    buffer_load_dwordx4 v[100:103], v1, s[60:63], s16 offen offset:2560 sc1
    s_add_u32 s16, s16, 5120
    buffer_load_dwordx4 v[72:75], v1, s[60:63], s16 offen offset:0 sc1
    buffer_load_dwordx4 v[104:107], v1, s[60:63], s16 offen offset:2560 sc1
    s_add_u32 s16, s16, 5120
    buffer_load_dwordx4 v[76:79], v1, s[60:63], s16 offen offset:0 sc1
    buffer_load_dwordx4 v[108:111], v1, s[60:63], s16 offen offset:2560 sc1
    s_add_u32 s16, s16, 5120
    buffer_load_dwordx4 v[80:83], v1, s[60:63], s16 offen offset:0 sc1
    buffer_load_dwordx4 v[112:115], v1, s[60:63], s16 offen offset:2560 sc1
    s_add_u32 s16, s16, 5120
    buffer_load_dwordx4 v[84:87], v1, s[60:63], s16 offen offset:0 sc1
    buffer_load_dwordx4 v[116:119], v1, s[60:63], s16 offen offset:2560 sc1
    s_add_u32 s16, s16, 5120
    buffer_load_dwordx4 v[88:91], v1, s[60:63], s16 offen offset:0 sc1
    buffer_load_dwordx4 v[120:123], v1, s[60:63], s16 offen offset:2560 sc1
    s_add_u32 s16, s16, 5120
    buffer_load_dwordx4 v[92:95], v1, s[60:63], s16 offen offset:0 sc1
    buffer_load_dwordx4 v[124:127], v1, s[60:63], s16 offen offset:2560 sc1
    s_mov_b64 exec, -1
P3_NOY0:
    s_mul_i32 s16, s29, 102400
    s_add_u32 s16, s16, s52
    s_add_u32 s16, s16, 11010048
    s_cmp_ge_u32 s55, 2
    s_cselect_b32 s17, 30720, 0
    s_add_u32 m0, s52, 0
    s_add_u32 s18, s16, 0
    buffer_load_dwordx4 v1, s[60:63], s18 offen sc1 lds
    s_add_u32 m0, s52, 4096
    s_add_u32 s18, s16, 4096
    buffer_load_dwordx4 v1, s[60:63], s18 offen sc1 lds
    s_add_u32 m0, s52, 8192
    s_add_u32 s18, s16, 8192
    buffer_load_dwordx4 v1, s[60:63], s18 offen sc1 lds
    s_add_u32 m0, s52, 12288
    s_add_u32 s18, s16, 12288
    buffer_load_dwordx4 v1, s[60:63], s18 offen sc1 lds
    s_add_u32 m0, s52, 16384
    s_add_u32 s18, s16, 16384
    buffer_load_dwordx4 v1, s[60:63], s18 offen sc1 lds
    s_add_u32 m0, s52, 20480
    s_add_u32 s18, s16, 20480
    buffer_load_dwordx4 v1, s[60:63], s18 offen sc1 lds
    s_add_u32 m0, s52, 24576
    s_add_u32 s18, s16, 24576
    buffer_load_dwordx4 v1, s[60:63], s18 offen sc1 lds
    s_add_u32 m0, s52, 28672
    s_add_u32 s18, s16, 28672
    buffer_load_dwordx4 v1, s[60:63], s18 offen sc1 lds
    s_add_u32 m0, s52, 32768
    s_add_u32 s18, s16, 32768
    buffer_load_dwordx4 v1, s[60:63], s18 offen sc1 lds
    s_add_u32 m0, s52, 36864
    s_add_u32 s18, s16, 36864
    buffer_load_dwordx4 v1, s[60:63], s18 offen sc1 lds
    s_add_u32 m0, s52, 40960
    s_add_u32 s18, s16, 40960
    buffer_load_dwordx4 v1, s[60:63], s18 offen sc1 lds
    s_add_u32 m0, s52, 45056
    s_add_u32 s18, s16, 45056
    buffer_load_dwordx4 v1, s[60:63], s18 offen sc1 lds
    s_add_u32 s17, s17, s52
    s_add_u32 m0, s17, 49152
    s_add_u32 s18, s16, 49152
    buffer_load_dwordx4 v1, s[60:63], s18 offen sc1 lds
    s_add_u32 m0, s52, 83968
    s_add_u32 s18, s16, 53248
    buffer_load_dwordx4 v1, s[60:63], s18 offen sc1 lds
    s_add_u32 m0, s52, 88064
    s_add_u32 s18, s16, 57344
    buffer_load_dwordx4 v1, s[60:63], s18 offen sc1 lds
    s_add_u32 m0, s52, 92160
    s_add_u32 s18, s16, 61440
    buffer_load_dwordx4 v1, s[60:63], s18 offen sc1 lds
    s_add_u32 m0, s52, 96256
    s_add_u32 s18, s16, 65536
    buffer_load_dwordx4 v1, s[60:63], s18 offen sc1 lds
    s_add_u32 m0, s52, 100352
    s_add_u32 s18, s16, 69632
    buffer_load_dwordx4 v1, s[60:63], s18 offen sc1 lds
    s_add_u32 m0, s52, 104448
    s_add_u32 s18, s16, 73728
    buffer_load_dwordx4 v1, s[60:63], s18 offen sc1 lds
    s_add_u32 m0, s52, 108544
    s_add_u32 s18, s16, 77824
    buffer_load_dwordx4 v1, s[60:63], s18 offen sc1 lds
    s_add_u32 m0, s52, 112640
    s_add_u32 s18, s16, 81920
    buffer_load_dwordx4 v1, s[60:63], s18 offen sc1 lds
    s_add_u32 m0, s52, 116736
    s_add_u32 s18, s16, 86016
    buffer_load_dwordx4 v1, s[60:63], s18 offen sc1 lds
    s_add_u32 m0, s52, 120832
    s_add_u32 s18, s16, 90112
    buffer_load_dwordx4 v1, s[60:63], s18 offen sc1 lds
    s_add_u32 m0, s52, 124928
    s_add_u32 s18, s16, 94208
    buffer_load_dwordx4 v1, s[60:63], s18 offen sc1 lds
    s_add_u32 m0, s52, 129024
    s_add_u32 s18, s16, 98304
    buffer_load_dwordx4 v1, s[60:63], s18 offen sc1 lds
    s_and_b32 s16, s22, -1
    s_and_b32 s17, s55, 0
    s_lshl_b32 s12, s16, 14
    s_lshl_b32 s18, s17, 13
    s_add_u32 s12, s12, s18
    s_add_u32 s12, s12, 7864320
    s_add_u32 s58, s12, 16384
    s_lshl_b32 s13, s16, 12
    s_lshl_b32 s18, s17, 11
    s_add_u32 s13, s13, s18
    s_add_u32 s13, s13, 9961472
    s_add_u32 s59, s13, 4096
    s_lshl_b32 s14, s28, 13
    s_add_u32 s14, s14, 10616832
    s_mul_i32 s15, s55, 640
    s_add_u32 s15, s15, 51200
    s_bitcmp1_b32 s23, 0
    s_cbranch_scc0 P3_NOY1
    s_lshr_b32 s16, s40, 31
    s_sub_u32 s16, s16, 1
    s_or_b32 s16, s16, 0x80000000
    s_xor_b32 s16, s16, s40
    s_and_b32 s16, s16, 0xffff0000
    v_mov_b32 v144, 0xbfb8aa3b
    v_mul_f32 v144, s16, v144
    v_exp_f32 v144, v144
    v_add_u32 v4, s15, v1
    v_add_f32 v144, 1.0, v144
    v_rcp_f32 v144, v144
    s_waitcnt vmcnt(25)
    v_cvt_pk_bf16_f32 v144, v144, v144
    v_and_b32 v144, 0xffff0000, v144
    v_add_f32 v64, v64, v68
    v_add_f32 v65, v65, v69
    v_add_f32 v66, v66, v70
    v_add_f32 v67, v67, v71
    v_add_f32 v64, v64, v72
    v_add_f32 v65, v65, v73
    v_add_f32 v66, v66, v74
    v_add_f32 v67, v67, v75
    v_add_f32 v64, v64, v76
    v_add_f32 v65, v65, v77
    v_add_f32 v66, v66, v78
    v_add_f32 v67, v67, v79
    v_add_f32 v64, v64, v80
    v_add_f32 v65, v65, v81
    v_add_f32 v66, v66, v82
    v_add_f32 v67, v67, v83
    v_add_f32 v64, v64, v84
    v_add_f32 v65, v65, v85
    v_add_f32 v66, v66, v86
    v_add_f32 v67, v67, v87
    v_add_f32 v64, v64, v88
    v_add_f32 v65, v65, v89
    v_add_f32 v66, v66, v90
    v_add_f32 v67, v67, v91
    v_add_f32 v64, v64, v92
    v_add_f32 v65, v65, v93
    v_add_f32 v66, v66, v94
    v_add_f32 v67, v67, v95
    v_cvt_pk_bf16_f32 v68, v64, v65
    v_cvt_pk_bf16_f32 v69, v66, v67
    v_lshlrev_b32 v64, 16, v68
    v_and_b32 v65, 0xffff0000, v68
    v_lshlrev_b32 v66, 16, v69
    v_and_b32 v67, 0xffff0000, v69
    v_mul_f32 v64, v64, v144
    v_mul_f32 v65, v65, v144
    v_mul_f32 v66, v66, v144
    v_mul_f32 v67, v67, v144
    v_cvt_pk_bf16_f32 v68, v64, v65
    v_cvt_pk_bf16_f32 v69, v66, v67
    v_lshlrev_b32 v64, 16, v68
    v_and_b32 v65, 0xffff0000, v68
    v_lshlrev_b32 v66, 16, v69
    v_and_b32 v67, 0xffff0000, v69
    s_mov_b64 exec, 0xfffff
    ds_write_b128 v4, v[64:67]
    s_mov_b64 exec, -1
    s_and_b32 s16, s42, 15
    s_waitcnt lgkmcnt(0)
    v_add_u32 v3, s15, v21
    ds_read_b128 v[64:67], v3
    ds_read_b128 v[68:71], v3 offset:16
    v_add_u32 v3, s15, v22
    ds_read_b128 v[72:75], v3
    ds_read_b128 v[76:79], v3 offset:16
    v_add_u32 v3, s15, v23
    ds_read_b128 v[80:83], v3
    ds_read_b128 v[84:87], v3 offset:16
    v_cmp_eq_u32 vcc, s16, v12
    s_nop 0
    s_and_saveexec_b64 s[18:19], vcc
    s_cbranch_execz P3_Y00
    s_waitcnt lgkmcnt(0)
    v_add_f32 v40, v40, v64
    v_add_f32 v41, v41, v65
    v_add_f32 v42, v42, v66
    v_add_f32 v43, v43, v67
    v_add_f32 v44, v44, v68
    v_add_f32 v45, v45, v69
    v_add_f32 v46, v46, v70
    v_add_f32 v47, v47, v71
P3_Y00:
    s_mov_b64 exec, -1
    v_cmp_eq_u32 vcc, s16, v13
    s_nop 0
    s_and_saveexec_b64 s[18:19], vcc
    s_cbranch_execz P3_Y01
    s_waitcnt lgkmcnt(0)
    v_add_f32 v48, v48, v72
    v_add_f32 v49, v49, v73
    v_add_f32 v50, v50, v74
    v_add_f32 v51, v51, v75
    v_add_f32 v52, v52, v76
    v_add_f32 v53, v53, v77
    v_add_f32 v54, v54, v78
    v_add_f32 v55, v55, v79
P3_Y01:
    s_mov_b64 exec, -1
    v_cmp_eq_u32 vcc, s16, v14
    s_nop 0
    s_and_saveexec_b64 s[18:19], vcc
    s_cbranch_execz P3_Y02
    s_waitcnt lgkmcnt(0)
    v_add_f32 v56, v56, v80
    v_add_f32 v57, v57, v81
    v_add_f32 v58, v58, v82
    v_add_f32 v59, v59, v83
    v_add_f32 v60, v60, v84
    v_add_f32 v61, v61, v85
    v_add_f32 v62, v62, v86
    v_add_f32 v63, v63, v87
P3_Y02:
    s_mov_b64 exec, -1
    s_waitcnt lgkmcnt(0)
P3_NOY1:
    s_bitcmp1_b32 s23, 1
    s_cbranch_scc0 P3_NOY2
    s_lshr_b32 s16, s41, 31
    s_sub_u32 s16, s16, 1
    s_or_b32 s16, s16, 0x80000000
    s_xor_b32 s16, s16, s41
    s_and_b32 s16, s16, 0xffff0000
    v_mov_b32 v144, 0xbfb8aa3b
    v_mul_f32 v144, s16, v144
    v_exp_f32 v144, v144
    v_add_u32 v4, s15, v1
    v_add_f32 v144, 1.0, v144
    v_rcp_f32 v144, v144
    s_waitcnt vmcnt(25)
    v_cvt_pk_bf16_f32 v144, v144, v144
    v_and_b32 v144, 0xffff0000, v144
    v_add_f32 v96, v96, v100
    v_add_f32 v97, v97, v101
    v_add_f32 v98, v98, v102
    v_add_f32 v99, v99, v103
    v_add_f32 v96, v96, v104
    v_add_f32 v97, v97, v105
    v_add_f32 v98, v98, v106
    v_add_f32 v99, v99, v107
    v_add_f32 v96, v96, v108
    v_add_f32 v97, v97, v109
    v_add_f32 v98, v98, v110
    v_add_f32 v99, v99, v111
    v_add_f32 v96, v96, v112
    v_add_f32 v97, v97, v113
    v_add_f32 v98, v98, v114
    v_add_f32 v99, v99, v115
    v_add_f32 v96, v96, v116
    v_add_f32 v97, v97, v117
    v_add_f32 v98, v98, v118
    v_add_f32 v99, v99, v119
    v_add_f32 v96, v96, v120
    v_add_f32 v97, v97, v121
    v_add_f32 v98, v98, v122
    v_add_f32 v99, v99, v123
    v_add_f32 v96, v96, v124
    v_add_f32 v97, v97, v125
    v_add_f32 v98, v98, v126
    v_add_f32 v99, v99, v127
    v_cvt_pk_bf16_f32 v100, v96, v97
    v_cvt_pk_bf16_f32 v101, v98, v99
    v_lshlrev_b32 v96, 16, v100
    v_and_b32 v97, 0xffff0000, v100
    v_lshlrev_b32 v98, 16, v101
    v_and_b32 v99, 0xffff0000, v101
    v_mul_f32 v96, v96, v144
    v_mul_f32 v97, v97, v144
    v_mul_f32 v98, v98, v144
    v_mul_f32 v99, v99, v144
    v_cvt_pk_bf16_f32 v100, v96, v97
    v_cvt_pk_bf16_f32 v101, v98, v99
    v_lshlrev_b32 v96, 16, v100
    v_and_b32 v97, 0xffff0000, v100
    v_lshlrev_b32 v98, 16, v101
    v_and_b32 v99, 0xffff0000, v101
    s_mov_b64 exec, 0xfffff
    ds_write_b128 v4, v[96:99]
    s_mov_b64 exec, -1
    s_and_b32 s16, s43, 15
    s_waitcnt lgkmcnt(0)
    v_add_u32 v3, s15, v21
    ds_read_b128 v[96:99], v3
    ds_read_b128 v[100:103], v3 offset:16
    v_add_u32 v3, s15, v22
    ds_read_b128 v[104:107], v3
    ds_read_b128 v[108:111], v3 offset:16
    v_add_u32 v3, s15, v23
    ds_read_b128 v[112:115], v3
    ds_read_b128 v[116:119], v3 offset:16
    v_cmp_eq_u32 vcc, s16, v12
    s_nop 0
    s_and_saveexec_b64 s[18:19], vcc
    s_cbranch_execz P3_Y10
    s_waitcnt lgkmcnt(0)
    v_add_f32 v40, v40, v96
    v_add_f32 v41, v41, v97
    v_add_f32 v42, v42, v98
    v_add_f32 v43, v43, v99
    v_add_f32 v44, v44, v100
    v_add_f32 v45, v45, v101
    v_add_f32 v46, v46, v102
    v_add_f32 v47, v47, v103
P3_Y10:
    s_mov_b64 exec, -1
    v_cmp_eq_u32 vcc, s16, v13
    s_nop 0
    s_and_saveexec_b64 s[18:19], vcc
    s_cbranch_execz P3_Y11
    s_waitcnt lgkmcnt(0)
    v_add_f32 v48, v48, v104
    v_add_f32 v49, v49, v105
    v_add_f32 v50, v50, v106
    v_add_f32 v51, v51, v107
    v_add_f32 v52, v52, v108
    v_add_f32 v53, v53, v109
    v_add_f32 v54, v54, v110
    v_add_f32 v55, v55, v111
P3_Y11:
    s_mov_b64 exec, -1
    v_cmp_eq_u32 vcc, s16, v14
    s_nop 0
    s_and_saveexec_b64 s[18:19], vcc
    s_cbranch_execz P3_Y12
    s_waitcnt lgkmcnt(0)
    v_add_f32 v56, v56, v112
    v_add_f32 v57, v57, v113
    v_add_f32 v58, v58, v114
    v_add_f32 v59, v59, v115
    v_add_f32 v60, v60, v116
    v_add_f32 v61, v61, v117
    v_add_f32 v62, v62, v118
    v_add_f32 v63, v63, v119
P3_Y12:
    s_mov_b64 exec, -1
    s_waitcnt lgkmcnt(0)
P3_NOY2:
    s_setprio 0
    v_mov_b32 v3, 133120
    s_waitcnt lgkmcnt(0)
    s_barrier
    s_waitcnt vmcnt(0)
    s_barrier
    s_cmp_lg_u32 s26, 0
    s_cbranch_scc1 P3
    s_barrier
    ds_read_b128 v[64:67], v3
    s_waitcnt lgkmcnt(0)
    v_or3_b32 v2, v64, v65, v66
    v_or_b32 v2, v2, v67
    s_nop 0
    v_readfirstlane_b32 s16, v2
    s_nop 0
    s_cmp_eq_u32 s16, 0
    s_cbranch_scc1 P3
    s_mov_b32 s26, 1
    s_barrier
    s_branch P2_STAGE
P3:
    ds_read_b128 v[164:167], v24 offset:0
    ds_read_b128 v[168:171], v24 offset:1024
    ds_read_b128 v[172:175], v24 offset:2048
    ds_read_b128 v[176:179], v24 offset:3072
    ds_read_b128 v[180:183], v24 offset:4096
    ds_read_b128 v[184:187], v24 offset:5120
    ds_read_b128 v[188:191], v24 offset:6144
    ds_read_b128 v[192:195], v24 offset:7168
    ds_read_b128 v[196:199], v24 offset:8192
    ds_read_b128 v[200:203], v24 offset:9216
    ds_read_b128 v[204:207], v24 offset:10240
    ds_read_b128 v[208:211], v24 offset:11264
    ds_read_b128 v[212:215], v24 offset:12288
    ds_read_b128 v[216:219], v24 offset:13312
    ds_read_b128 v[220:223], v24 offset:14336
    ds_read_b128 v[224:227], v24 offset:15360
    ds_read_b128 v[228:231], v24 offset:16384
    ds_read_b128 v[232:235], v24 offset:17408
    ds_read_b128 v[236:239], v24 offset:18432
    ds_read_b128 v[240:243], v24 offset:19456
    s_barrier
    s_cmp_lg_u32 s3, 4
    s_cbranch_scc1 P3_GO
    s_mov_b32 s19, 0
POLL10:
    buffer_load_dword v3, v30, s[60:63], s14 offen sc1
    s_add_u32 s19, s19, 1
    s_cmp_gt_u32 s19, 200000
    s_cbranch_scc1 POLLX10
    s_waitcnt vmcnt(0)
    v_cmp_eq_u32 vcc, 0, v3
    s_nop 0
    s_mov_b64 exec, vcc
    s_cbranch_execnz POLL10
POLLX10:
    s_mov_b64 exec, -1
    s_waitcnt vmcnt(0)
P3_GO:
    s_barrier
    buffer_load_dwordx4 v[64:67], v1, s[60:63], s12 offen offset:0 sc1
    buffer_load_dwordx4 v[68:71], v1, s[60:63], s12 offen offset:1024 sc1
    buffer_load_dwordx4 v[72:75], v1, s[60:63], s12 offen offset:2048 sc1
    buffer_load_dwordx4 v[76:79], v1, s[60:63], s12 offen offset:3072 sc1
    s_add_u32 s12, s12, 4096
    buffer_load_dwordx4 v[80:83], v1, s[60:63], s12 offen offset:0 sc1
    buffer_load_dwordx4 v[84:87], v1, s[60:63], s12 offen offset:1024 sc1
    buffer_load_dwordx4 v[88:91], v1, s[60:63], s12 offen offset:2048 sc1
    buffer_load_dwordx4 v[92:95], v1, s[60:63], s12 offen offset:3072 sc1
    s_add_u32 s12, s12, 4096
    buffer_load_dwordx2 v[96:97], v28, s[60:63], s13 offen offset:0 sc1
    buffer_load_dwordx2 v[98:99], v28, s[60:63], s13 offen offset:128 sc1
    buffer_load_dwordx2 v[100:101], v28, s[60:63], s13 offen offset:1024 sc1
    buffer_load_dwordx2 v[102:103], v28, s[60:63], s13 offen offset:1152 sc1
    s_waitcnt vmcnt(11) lgkmcnt(15)
    v_mfma_f32_16x16x32_bf16 v[144:147], v[164:167], v[64:67], 0
    ds_read_b128 v[164:167], v24 offset:20480
    v_mfma_f32_16x16x32_bf16 v[148:151], v[168:171], v[64:67], 0
    ds_read_b128 v[168:171], v24 offset:21504
    v_mfma_f32_16x16x32_bf16 v[152:155], v[172:175], v[64:67], 0
    ds_read_b128 v[172:175], v24 offset:22528
    v_mfma_f32_16x16x32_bf16 v[156:159], v[176:179], v[64:67], 0
    ds_read_b128 v[176:179], v24 offset:23552
    v_mfma_f32_16x16x32_bf16 v[160:163], v[180:183], v[64:67], 0
    ds_read_b128 v[180:183], v24 offset:24576
    buffer_load_dwordx4 v[104:107], v1, s[60:63], s12 offen offset:0 sc1
    s_waitcnt vmcnt(11) lgkmcnt(15)
    v_mfma_f32_16x16x32_bf16 v[144:147], v[184:187], v[68:71], v[144:147]
    ds_read_b128 v[184:187], v24 offset:25600
    v_mfma_f32_16x16x32_bf16 v[148:151], v[188:191], v[68:71], v[148:151]
    ds_read_b128 v[188:191], v24 offset:26624
    v_mfma_f32_16x16x32_bf16 v[152:155], v[192:195], v[68:71], v[152:155]
    ds_read_b128 v[192:195], v24 offset:27648
    v_mfma_f32_16x16x32_bf16 v[156:159], v[196:199], v[68:71], v[156:159]
    ds_read_b128 v[196:199], v24 offset:28672
    v_mfma_f32_16x16x32_bf16 v[160:163], v[200:203], v[68:71], v[160:163]
    ds_read_b128 v[200:203], v24 offset:29696
    buffer_load_dwordx4 v[108:111], v1, s[60:63], s12 offen offset:1024 sc1
    s_waitcnt vmcnt(11) lgkmcnt(15)
    v_mfma_f32_16x16x32_bf16 v[144:147], v[204:207], v[72:75], v[144:147]
    ds_read_b128 v[204:207], v24 offset:30720
    v_mfma_f32_16x16x32_bf16 v[148:151], v[208:211], v[72:75], v[148:151]
    ds_read_b128 v[208:211], v24 offset:31744
    v_mfma_f32_16x16x32_bf16 v[152:155], v[212:215], v[72:75], v[152:155]
    ds_read_b128 v[212:215], v24 offset:32768
    v_mfma_f32_16x16x32_bf16 v[156:159], v[216:219], v[72:75], v[156:159]
    ds_read_b128 v[216:219], v24 offset:33792
    v_mfma_f32_16x16x32_bf16 v[160:163], v[220:223], v[72:75], v[160:163]
    ds_read_b128 v[220:223], v24 offset:34816
    buffer_load_dwordx4 v[112:115], v1, s[60:63], s12 offen offset:2048 sc1
    s_waitcnt vmcnt(11) lgkmcnt(15)
    v_mfma_f32_16x16x32_bf16 v[144:147], v[224:227], v[76:79], v[144:147]
    ds_read_b128 v[224:227], v24 offset:35840
    v_mfma_f32_16x16x32_bf16 v[148:151], v[228:231], v[76:79], v[148:151]
    ds_read_b128 v[228:231], v24 offset:36864
    v_mfma_f32_16x16x32_bf16 v[152:155], v[232:235], v[76:79], v[152:155]
    ds_read_b128 v[232:235], v24 offset:37888
    v_mfma_f32_16x16x32_bf16 v[156:159], v[236:239], v[76:79], v[156:159]
    ds_read_b128 v[236:239], v24 offset:38912
    v_mfma_f32_16x16x32_bf16 v[160:163], v[240:243], v[76:79], v[160:163]
    ds_read_b128 v[240:243], v24 offset:39936
    buffer_load_dwordx4 v[116:119], v1, s[60:63], s12 offen offset:3072 sc1
    s_add_u32 s12, s12, 4096
    s_waitcnt vmcnt(11) lgkmcnt(15)
    v_mfma_f32_16x16x32_bf16 v[144:147], v[164:167], v[80:83], v[144:147]
    ds_read_b128 v[164:167], v24 offset:40960
    v_mfma_f32_16x16x32_bf16 v[148:151], v[168:171], v[80:83], v[148:151]
    ds_read_b128 v[168:171], v24 offset:41984
    v_mfma_f32_16x16x32_bf16 v[152:155], v[172:175], v[80:83], v[152:155]
    ds_read_b128 v[172:175], v24 offset:43008
    v_mfma_f32_16x16x32_bf16 v[156:159], v[176:179], v[80:83], v[156:159]
    ds_read_b128 v[176:179], v24 offset:44032
    v_mfma_f32_16x16x32_bf16 v[160:163], v[180:183], v[80:83], v[160:163]
    ds_read_b128 v[180:183], v24 offset:45056
    buffer_load_dwordx4 v[120:123], v1, s[60:63], s12 offen offset:0 sc1
    s_waitcnt vmcnt(11) lgkmcnt(15)
    v_mfma_f32_16x16x32_bf16 v[144:147], v[184:187], v[84:87], v[144:147]
    ds_read_b128 v[184:187], v24 offset:46080
    v_mfma_f32_16x16x32_bf16 v[148:151], v[188:191], v[84:87], v[148:151]
    ds_read_b128 v[188:191], v24 offset:47104
    v_mfma_f32_16x16x32_bf16 v[152:155], v[192:195], v[84:87], v[152:155]
    ds_read_b128 v[192:195], v24 offset:48128
    v_mfma_f32_16x16x32_bf16 v[156:159], v[196:199], v[84:87], v[156:159]
    ds_read_b128 v[196:199], v24 offset:49152
    v_mfma_f32_16x16x32_bf16 v[160:163], v[200:203], v[84:87], v[160:163]
    ds_read_b128 v[200:203], v24 offset:50176
    buffer_load_dwordx4 v[124:127], v1, s[60:63], s12 offen offset:1024 sc1
    s_waitcnt vmcnt(11) lgkmcnt(15)
    v_mfma_f32_16x16x32_bf16 v[144:147], v[204:207], v[88:91], v[144:147]
    ds_read_b128 v[204:207], v25 offset:0
    v_mfma_f32_16x16x32_bf16 v[148:151], v[208:211], v[88:91], v[148:151]
    ds_read_b128 v[208:211], v25 offset:1024
    v_mfma_f32_16x16x32_bf16 v[152:155], v[212:215], v[88:91], v[152:155]
    ds_read_b128 v[212:215], v25 offset:2048
    v_mfma_f32_16x16x32_bf16 v[156:159], v[216:219], v[88:91], v[156:159]
    ds_read_b128 v[216:219], v25 offset:3072
    v_mfma_f32_16x16x32_bf16 v[160:163], v[220:223], v[88:91], v[160:163]
    ds_read_b128 v[220:223], v25 offset:4096
    buffer_load_dwordx4 v[128:131], v1, s[60:63], s12 offen offset:2048 sc1
    s_waitcnt vmcnt(11) lgkmcnt(15)
    v_mfma_f32_16x16x32_bf16 v[144:147], v[224:227], v[92:95], v[144:147]
    ds_read_b128 v[224:227], v25 offset:5120
    v_mfma_f32_16x16x32_bf16 v[148:151], v[228:231], v[92:95], v[148:151]
    ds_read_b128 v[228:231], v25 offset:6144
    v_mfma_f32_16x16x32_bf16 v[152:155], v[232:235], v[92:95], v[152:155]
    ds_read_b128 v[232:235], v25 offset:7168
    v_mfma_f32_16x16x32_bf16 v[156:159], v[236:239], v[92:95], v[156:159]
    ds_read_b128 v[236:239], v25 offset:8192
    v_mfma_f32_16x16x32_bf16 v[160:163], v[240:243], v[92:95], v[160:163]
    ds_read_b128 v[240:243], v25 offset:9216
    buffer_load_dwordx4 v[132:135], v1, s[60:63], s12 offen offset:3072 sc1
    s_add_u32 s12, s12, 4096
    s_waitcnt vmcnt(10) lgkmcnt(15)
    v_mfma_f32_16x16x32_bf16 v[144:147], v[164:167], v[96:99], v[144:147]
    ds_read_b128 v[164:167], v25 offset:10240
    v_mfma_f32_16x16x32_bf16 v[148:151], v[168:171], v[96:99], v[148:151]
    ds_read_b128 v[168:171], v25 offset:11264
    v_mfma_f32_16x16x32_bf16 v[152:155], v[172:175], v[96:99], v[152:155]
    ds_read_b128 v[172:175], v25 offset:12288
    v_mfma_f32_16x16x32_bf16 v[156:159], v[176:179], v[96:99], v[156:159]
    ds_read_b128 v[176:179], v25 offset:13312
    v_mfma_f32_16x16x32_bf16 v[160:163], v[180:183], v[96:99], v[160:163]
    ds_read_b128 v[180:183], v25 offset:14336
    buffer_load_dwordx2 v[136:137], v28, s[60:63], s13 offen offset:2048 sc1
    buffer_load_dwordx2 v[138:139], v28, s[60:63], s13 offen offset:2176 sc1
    s_waitcnt vmcnt(10) lgkmcnt(15)
    v_mfma_f32_16x16x32_bf16 v[144:147], v[184:187], v[100:103], v[144:147]
    ds_read_b128 v[184:187], v25 offset:15360
    v_mfma_f32_16x16x32_bf16 v[148:151], v[188:191], v[100:103], v[148:151]
    ds_read_b128 v[188:191], v25 offset:16384
    v_mfma_f32_16x16x32_bf16 v[152:155], v[192:195], v[100:103], v[152:155]
    ds_read_b128 v[192:195], v25 offset:17408
    v_mfma_f32_16x16x32_bf16 v[156:159], v[196:199], v[100:103], v[156:159]
    ds_read_b128 v[196:199], v25 offset:18432
    v_mfma_f32_16x16x32_bf16 v[160:163], v[200:203], v[100:103], v[160:163]
    ds_read_b128 v[200:203], v25 offset:19456
    buffer_load_dwordx2 v[140:141], v28, s[60:63], s13 offen offset:3072 sc1
    buffer_load_dwordx2 v[142:143], v28, s[60:63], s13 offen offset:3200 sc1
    s_waitcnt vmcnt(11) lgkmcnt(15)
    v_mfma_f32_16x16x32_bf16 v[144:147], v[204:207], v[104:107], v[144:147]
    ds_read_b128 v[204:207], v25 offset:20480
    v_mfma_f32_16x16x32_bf16 v[148:151], v[208:211], v[104:107], v[148:151]
    ds_read_b128 v[208:211], v25 offset:21504
    v_mfma_f32_16x16x32_bf16 v[152:155], v[212:215], v[104:107], v[152:155]
    ds_read_b128 v[212:215], v25 offset:22528
    v_mfma_f32_16x16x32_bf16 v[156:159], v[216:219], v[104:107], v[156:159]
    ds_read_b128 v[216:219], v25 offset:23552
    v_mfma_f32_16x16x32_bf16 v[160:163], v[220:223], v[104:107], v[160:163]
    ds_read_b128 v[220:223], v25 offset:24576
    s_waitcnt vmcnt(10) lgkmcnt(15)
    v_mfma_f32_16x16x32_bf16 v[144:147], v[224:227], v[108:111], v[144:147]
    ds_read_b128 v[224:227], v25 offset:25600
    v_mfma_f32_16x16x32_bf16 v[148:151], v[228:231], v[108:111], v[148:151]
    ds_read_b128 v[228:231], v25 offset:26624
    v_mfma_f32_16x16x32_bf16 v[152:155], v[232:235], v[108:111], v[152:155]
    ds_read_b128 v[232:235], v25 offset:27648
    v_mfma_f32_16x16x32_bf16 v[156:159], v[236:239], v[108:111], v[156:159]
    ds_read_b128 v[236:239], v25 offset:28672
    v_mfma_f32_16x16x32_bf16 v[160:163], v[240:243], v[108:111], v[160:163]
    ds_read_b128 v[240:243], v25 offset:29696
    s_waitcnt vmcnt(9) lgkmcnt(15)
    v_mfma_f32_16x16x32_bf16 v[144:147], v[164:167], v[112:115], v[144:147]
    ds_read_b128 v[164:167], v25 offset:30720
    v_mfma_f32_16x16x32_bf16 v[148:151], v[168:171], v[112:115], v[148:151]
    ds_read_b128 v[168:171], v25 offset:31744
    v_mfma_f32_16x16x32_bf16 v[152:155], v[172:175], v[112:115], v[152:155]
    ds_read_b128 v[172:175], v25 offset:32768
    v_mfma_f32_16x16x32_bf16 v[156:159], v[176:179], v[112:115], v[156:159]
    ds_read_b128 v[176:179], v25 offset:33792
    v_mfma_f32_16x16x32_bf16 v[160:163], v[180:183], v[112:115], v[160:163]
    ds_read_b128 v[180:183], v25 offset:34816
    s_waitcnt vmcnt(8) lgkmcnt(15)
    v_mfma_f32_16x16x32_bf16 v[144:147], v[184:187], v[116:119], v[144:147]
    ds_read_b128 v[184:187], v25 offset:35840
    v_mfma_f32_16x16x32_bf16 v[148:151], v[188:191], v[116:119], v[148:151]
    ds_read_b128 v[188:191], v25 offset:36864
    v_mfma_f32_16x16x32_bf16 v[152:155], v[192:195], v[116:119], v[152:155]
    ds_read_b128 v[192:195], v25 offset:37888
    v_mfma_f32_16x16x32_bf16 v[156:159], v[196:199], v[116:119], v[156:159]
    ds_read_b128 v[196:199], v25 offset:38912
    v_mfma_f32_16x16x32_bf16 v[160:163], v[200:203], v[116:119], v[160:163]
    ds_read_b128 v[200:203], v25 offset:39936
    s_waitcnt vmcnt(7) lgkmcnt(15)
    v_mfma_f32_16x16x32_bf16 v[144:147], v[204:207], v[120:123], v[144:147]
    ds_read_b128 v[204:207], v25 offset:40960
    v_mfma_f32_16x16x32_bf16 v[148:151], v[208:211], v[120:123], v[148:151]
    ds_read_b128 v[208:211], v25 offset:41984
    v_mfma_f32_16x16x32_bf16 v[152:155], v[212:215], v[120:123], v[152:155]
    ds_read_b128 v[212:215], v25 offset:43008
    v_mfma_f32_16x16x32_bf16 v[156:159], v[216:219], v[120:123], v[156:159]
    ds_read_b128 v[216:219], v25 offset:44032
    v_mfma_f32_16x16x32_bf16 v[160:163], v[220:223], v[120:123], v[160:163]
    ds_read_b128 v[220:223], v25 offset:45056
    s_waitcnt vmcnt(6) lgkmcnt(15)
    v_mfma_f32_16x16x32_bf16 v[144:147], v[224:227], v[124:127], v[144:147]
    ds_read_b128 v[224:227], v25 offset:46080
    v_mfma_f32_16x16x32_bf16 v[148:151], v[228:231], v[124:127], v[148:151]
    ds_read_b128 v[228:231], v25 offset:47104
    v_mfma_f32_16x16x32_bf16 v[152:155], v[232:235], v[124:127], v[152:155]
    ds_read_b128 v[232:235], v25 offset:48128
    v_mfma_f32_16x16x32_bf16 v[156:159], v[236:239], v[124:127], v[156:159]
    ds_read_b128 v[236:239], v25 offset:49152
    v_mfma_f32_16x16x32_bf16 v[160:163], v[240:243], v[124:127], v[160:163]
    ds_read_b128 v[240:243], v25 offset:50176
    s_waitcnt vmcnt(5) lgkmcnt(15)
    v_mfma_f32_16x16x32_bf16 v[144:147], v[164:167], v[128:131], v[144:147]
    v_mfma_f32_16x16x32_bf16 v[148:151], v[168:171], v[128:131], v[148:151]
    v_mfma_f32_16x16x32_bf16 v[152:155], v[172:175], v[128:131], v[152:155]
    v_mfma_f32_16x16x32_bf16 v[156:159], v[176:179], v[128:131], v[156:159]
    v_mfma_f32_16x16x32_bf16 v[160:163], v[180:183], v[128:131], v[160:163]
    s_waitcnt vmcnt(4) lgkmcnt(10)
    v_mfma_f32_16x16x32_bf16 v[144:147], v[184:187], v[132:135], v[144:147]
    v_mfma_f32_16x16x32_bf16 v[148:151], v[188:191], v[132:135], v[148:151]
    v_mfma_f32_16x16x32_bf16 v[152:155], v[192:195], v[132:135], v[152:155]
    v_mfma_f32_16x16x32_bf16 v[156:159], v[196:199], v[132:135], v[156:159]
    v_mfma_f32_16x16x32_bf16 v[160:163], v[200:203], v[132:135], v[160:163]
    s_waitcnt vmcnt(2) lgkmcnt(5)
    v_mfma_f32_16x16x32_bf16 v[144:147], v[204:207], v[136:139], v[144:147]
    v_mfma_f32_16x16x32_bf16 v[148:151], v[208:211], v[136:139], v[148:151]
    v_mfma_f32_16x16x32_bf16 v[152:155], v[212:215], v[136:139], v[152:155]
    v_mfma_f32_16x16x32_bf16 v[156:159], v[216:219], v[136:139], v[156:159]
    v_mfma_f32_16x16x32_bf16 v[160:163], v[220:223], v[136:139], v[160:163]
    s_waitcnt vmcnt(0) lgkmcnt(0)
    v_mfma_f32_16x16x32_bf16 v[144:147], v[224:227], v[140:143], v[144:147]
    v_mfma_f32_16x16x32_bf16 v[148:151], v[228:231], v[140:143], v[148:151]
    v_mfma_f32_16x16x32_bf16 v[152:155], v[232:235], v[140:143], v[152:155]
    v_mfma_f32_16x16x32_bf16 v[156:159], v[236:239], v[140:143], v[156:159]
    v_mfma_f32_16x16x32_bf16 v[160:163], v[240:243], v[140:143], v[160:163]
    s_nop 3
    ds_write_b128 v29, v[144:147] offset:0
    ds_write_b128 v29, v[148:151] offset:64
    ds_write_b128 v29, v[152:155] offset:128
    ds_write_b128 v29, v[156:159] offset:192
    ds_write_b128 v29, v[160:163] offset:256
    s_waitcnt lgkmcnt(0)
    ds_read_b128 v[164:167], v18
    ds_read_b128 v[168:171], v18 offset:16
    ds_read_b128 v[172:175], v19
    ds_read_b128 v[176:179], v19 offset:16
    ds_read_b128 v[180:183], v20
    ds_read_b128 v[184:187], v20 offset:16
    s_waitcnt lgkmcnt(4)
    v_pk_add_f32 v[164:165], v[164:165], v[40:41]
    v_pk_add_f32 v[166:167], v[166:167], v[42:43]
    v_pk_add_f32 v[168:169], v[168:169], v[44:45]
    v_pk_add_f32 v[170:171], v[170:171], v[46:47]
    v_cvt_pk_bf16_f32 v64, v164, v165
    v_cvt_pk_bf16_f32 v65, v166, v167
    v_cvt_pk_bf16_f32 v66, v168, v169
    v_cvt_pk_bf16_f32 v67, v170, v171
    buffer_store_dwordx4 v[64:67], v15, s[8:11], s56 offen
    s_waitcnt lgkmcnt(2)
    v_pk_add_f32 v[172:173], v[172:173], v[48:49]
    v_pk_add_f32 v[174:175], v[174:175], v[50:51]
    v_pk_add_f32 v[176:177], v[176:177], v[52:53]
    v_pk_add_f32 v[178:179], v[178:179], v[54:55]
    v_cvt_pk_bf16_f32 v68, v172, v173
    v_cvt_pk_bf16_f32 v69, v174, v175
    v_cvt_pk_bf16_f32 v70, v176, v177
    v_cvt_pk_bf16_f32 v71, v178, v179
    buffer_store_dwordx4 v[68:71], v16, s[8:11], s56 offen
    s_waitcnt lgkmcnt(0)
    v_pk_add_f32 v[180:181], v[180:181], v[56:57]
    v_pk_add_f32 v[182:183], v[182:183], v[58:59]
    v_pk_add_f32 v[184:185], v[184:185], v[60:61]
    v_pk_add_f32 v[186:187], v[186:187], v[62:63]
    v_cvt_pk_bf16_f32 v72, v180, v181
    v_cvt_pk_bf16_f32 v73, v182, v183
    v_cvt_pk_bf16_f32 v74, v184, v185
    v_cvt_pk_bf16_f32 v75, v186, v187
    buffer_store_dwordx4 v[72:75], v17, s[8:11], s56 offen
P_END:
    s_endpgm
K_END:
.section .rodata,"a"
.p2align 6
.amdhsa_kernel parallel_sum__softmax_full_mha__moe_arch_mod__prompt_kernel
  .amdhsa_next_free_vgpr 244
  .amdhsa_next_free_sgpr 90
  .amdhsa_accum_offset 244
  .amdhsa_group_segment_fixed_size 0
  .amdhsa_kernarg_size 88
  .amdhsa_user_sgpr_count 2
  .amdhsa_user_sgpr_kernarg_segment_ptr 1
  .amdhsa_system_sgpr_workgroup_id_x 1
  .amdhsa_float_denorm_mode_32 3
.end_amdhsa_kernel
```
